```python
import torch

def _softmax(x, axis=-1):
    return torch.softmax(x, dim=axis)
def _gelu(x):
    return torch.nn.functional.gelu(x, approximate="tanh")
def _silu(x):
    return torch.nn.functional.silu(x)
def _sigmoid(x):
    return torch.sigmoid(x)
def _layernorm(x, axis=-1, eps=1e-5):
    m = x.mean(dim=axis, keepdim=True)
    v = x.var(dim=axis, keepdim=True, unbiased=False)
    return (x - m) / torch.sqrt(v + eps)
def _scatter_add(tgt, idx, src, axis=0):
    return tgt.clone().index_add_(axis, idx, src)
def _segment_sum(src, seg, n):
    out = torch.zeros((n,) + src.shape[1:], dtype=src.dtype)
    return out.index_add_(0, seg, src)
def _pad(x, pw):
    flat = tuple(v for pair in reversed(pw) for v in pair)
    return torch.nn.functional.pad(x, flat)

kernel_name = 'standalone__paged_block_table_kv_radixattention__decode'

def setup_inputs():

    _w = (lambda a: (lambda t: t.to(torch.bfloat16) if t.is_floating_point() else t)(torch.as_tensor(a)))
    B, H, Hkv, Dh = 2, 16, 8, 256
    Lk = 32768
    bs = 16
    nb = max(2, Lk // bs)
    P = max(1, nb // 2)
    n_phys = P + B * (nb - P)
    shared = torch.arange(P, dtype=torch.int64)
    priv = P + torch.arange(B * (nb - P), dtype=torch.int64).reshape(B, nb - P)
    bt = torch.cat([torch.tile(shared[None, :], (B, 1)), priv], dim=1)
    ctx = nb * bs - (torch.arange(1, B + 1, dtype=torch.int64) * 2654435761) % max(1, (nb * bs - P * bs) // 2)
    return {
        "q": _w((lambda *s: torch.randn(*s, dtype=torch.bfloat16) * 0.8)(B, H, Dh)),
        "k_cache": _w((lambda *s: torch.randn(*s, dtype=torch.bfloat16) * 0.8)(n_phys, bs, Hkv, Dh)),
        "v_cache": _w((lambda *s: torch.randn(*s, dtype=torch.bfloat16) * 0.05)(n_phys, bs, Hkv, Dh)),
        "block_table": _w(bt.to(torch.int64)),
        "ctx_lens": _w(torch.as_tensor(ctx).to(torch.int64)),
    }

def reference(q, k_cache, v_cache, block_table, ctx_lens):
    B, H, Dh = q.shape
    n_phys, bs, Hkv, _ = k_cache.shape
    nb = block_table.shape[1]
    Lk = nb * bs
    rep = H // Hkv
    k = k_cache[block_table].reshape(B, Lk, Hkv, Dh)
    v = v_cache[block_table].reshape(B, Lk, Hkv, Dh)
    k = (lambda x, n, axis: torch.repeat_interleave(x, n, dim=axis))(k, rep, axis=2)
    v = (lambda x, n, axis: torch.repeat_interleave(x, n, dim=axis))(v, rep, axis=2)
    scores = torch.einsum("bhd,bkhd->bhk", q, k) * (Dh ** -0.5)
    pos = torch.arange(Lk)
    valid = pos[None, :] < ctx_lens[:, None]
    scores = torch.where(valid[:, None, :], scores, -1e9)
    p = _softmax(scores, axis=-1)
    return torch.einsum("bhk,bkhd->bhd", p, v)
```

```asm
; @launch grid=(256,1,1) block=(320,1,1) lds=49664
.amdgcn_target "amdgcn-amd-amdhsa--gfx950"
.text
.globl standalone__paged_block_table_kv_radixattention__decode_kernel
.p2align 8
.type standalone__paged_block_table_kv_radixattention__decode_kernel,@function
standalone__paged_block_table_kv_radixattention__decode_kernel:
    s_cmp_ge_u32 s2, 256
    s_cbranch_scc1 L_end
    s_load_dwordx16 s[4:19], s[0:1], 0
    v_and_b32 v15, 63, v0
    v_lshrrev_b32 v1, 6, v0
    s_bfe_u32 s30, s2, 0x20003
    v_readfirstlane_b32 s32, v1
    s_lshr_b32 s50, s2, 5
    s_and_b32 s31, s2, 7
    s_lshl3_add_u32 s31, s50, s31
    s_lshr_b32 s50, s31, 6
    s_lshl_b32 s50, s50, 9
    s_and_b32 s83, s31, 63
    s_add_u32 s83, s83, s50
    s_lshl_b32 s50, s83, 2
    s_cmp_eq_u32 s32, 4
    s_cbranch_scc1 L_sched
    s_lshr_b32 s51, s32, 1
    s_lshl1_add_u32 s3, s30, s51
    s_lshl_b32 s68, s3, 9
    s_xor_b32 s69, s68, 512
    s_lshl_b32 s52, s32, 2
    v_lshrrev_b32 v57, 4, v15
    v_and_b32 v58, 3, v15
    v_lshlrev_b32 v58, 4, v58
    v_lshl_add_u32 v58, v57, 6, v58
    v_bfe_u32 v2, v15, 2, 2
    v_add_u32 v2, s52, v2
    v_lshl_add_u32 v2, v2, 12, v58
    v_lshrrev_b32 v5, 2, v15
    v_xor_b32 v5, s32, v5
    v_and_b32 v5, 1, v5
    v_bfe_u32 v56, v15, 3, 1
    v_lshl_add_u32 v59, v56, 9, v58
    v_lshl_add_u32 v59, v5, 13, v59
    v_lshl_add_u32 v60, s69, 1, v59
    v_lshl_add_u32 v59, s68, 1, v59
    s_mov_b32 s22, 0xc000000
    s_mov_b32 s23, 0x20000
    s_mov_b32 s26, 0xc000000
    s_mov_b32 s27, 0x20000
    s_lshl_b32 s51, s83, 16
    v_or_b32 v13, s51, v2
    v_add_u32 v14, 0x2000000, v13
    s_waitcnt lgkmcnt(0)
    s_load_dwordx2 s[28:29], s[12:13], 0
    s_load_dword s70, s[10:11], s50 offset:0
    s_load_dword s71, s[10:11], s50 offset:8192
    s_load_dword s72, s[10:11], s50 offset:2048
    s_load_dword s73, s[10:11], s50 offset:10240
    s_load_dword s74, s[10:11], s50 offset:256
    s_load_dword s75, s[10:11], s50 offset:8448
    s_load_dword s76, s[10:11], s50 offset:2304
    s_load_dword s77, s[10:11], s50 offset:10496
    s_and_b32 s7, s7, 0xffff
    s_and_b32 s9, s9, 0xffff
    s_mov_b64 s[20:21], s[6:7]
    s_mov_b64 s[24:25], s[6:7]
    global_load_dwordx4 v[20:23], v59, s[4:5] offset:0
    global_load_dwordx4 v[24:27], v59, s[4:5] offset:256
    global_load_dwordx4 v[28:31], v60, s[4:5] offset:0
    global_load_dwordx4 v[32:35], v60, s[4:5] offset:256
    buffer_load_dwordx4 v[104:107], v13, s[20:23], s68 offen offset:0 nt
    buffer_load_dwordx4 v[108:111], v13, s[20:23], s68 offen offset:256 nt
    buffer_load_dwordx4 v[112:115], v13, s[20:23], s69 offen offset:0 nt
    buffer_load_dwordx4 v[116:119], v13, s[20:23], s69 offen offset:256 nt
    buffer_load_dwordx4 v[120:123], v14, s[24:27], s68 offen offset:0 nt
    buffer_load_dwordx4 v[124:127], v14, s[24:27], s68 offen offset:256 nt
    buffer_load_dwordx4 v[128:131], v14, s[24:27], s69 offen offset:0 nt
    buffer_load_dwordx4 v[132:135], v14, s[24:27], s69 offen offset:256 nt
    v_add_u32 v13, 0x400000, v13
    v_add_u32 v14, 0x400000, v14
    buffer_load_dwordx4 v[136:139], v13, s[20:23], s68 offen offset:0 nt
    buffer_load_dwordx4 v[140:143], v13, s[20:23], s68 offen offset:256 nt
    buffer_load_dwordx4 v[144:147], v13, s[20:23], s69 offen offset:0 nt
    buffer_load_dwordx4 v[148:151], v13, s[20:23], s69 offen offset:256 nt
    buffer_load_dwordx4 v[152:155], v14, s[24:27], s68 offen offset:0 nt
    buffer_load_dwordx4 v[156:159], v14, s[24:27], s68 offen offset:256 nt
    buffer_load_dwordx4 v[160:163], v14, s[24:27], s69 offen offset:0 nt
    buffer_load_dwordx4 v[164:167], v14, s[24:27], s69 offen offset:256 nt
    s_lshl_b32 s50, s31, 2
    s_load_dword s88, s[10:11], s50 offset:0
    s_load_dword s89, s[10:11], s50 offset:8192
    s_load_dword s90, s[10:11], s50 offset:256
    s_load_dword s91, s[10:11], s50 offset:8448
    s_load_dword s92, s[10:11], s50 offset:512
    s_load_dword s93, s[10:11], s50 offset:8704
    s_load_dword s94, s[10:11], s50 offset:768
    s_load_dword s95, s[10:11], s50 offset:8960
    s_lshl_b32 s52, s32, 2
    v_add_u32 v4, s52, v57
    v_and_b32 v3, 15, v15
    v_lshlrev_b32 v3, 4, v3
    v_lshl_add_u32 v3, v4, 12, v3
    s_lshl_b32 s52, s32, 8
    s_add_u32 s52, s52, 25088
    v_lshl_add_u32 v7, v15, 2, s52
    s_mov_b32 s33, 0x3db8aa3b
    s_mov_b32 s38, 0
    s_mov_b32 s67, 0
    s_mov_b32 s78, 0xaaaaaaaa
    s_mov_b32 s79, 0xaaaaaaaa
    s_mov_b32 s80, 0xcccccccc
    s_mov_b32 s81, 0xcccccccc
    v_lshlrev_b32 v5, 3, v5
    v_mov_b32 v12, 0xff800000
    v_and_b32 v61, 1, v15
    v_lshlrev_b32 v61, 4, v61
    v_mov_b32 v62, 0xffff
    v_lshlrev_b32 v61, v61, v62
    v_bfe_u32 v62, v15, 1, 2
    v_cmp_eq_u32 vcc, 0, v62
    s_nop 1
    v_cndmask_b32 v16, 0, v61, vcc
    v_cmp_eq_u32 vcc, 1, v62
    s_nop 1
    v_cndmask_b32 v17, 0, v61, vcc
    v_cmp_eq_u32 vcc, 2, v62
    s_nop 1
    v_cndmask_b32 v18, 0, v61, vcc
    v_cmp_eq_u32 vcc, 3, v62
    s_nop 1
    v_cndmask_b32 v19, 0, v61, vcc
    v_mov_b32 v8, 0xf149f2ca
    v_mov_b32 v10, 0
    v_mov_b32 v9, 0xf149f2ca
    v_mov_b32 v11, 0
    v_mov_b32 v72, 0
    v_mov_b32 v73, 0
    v_mov_b32 v74, 0
    v_mov_b32 v75, 0
    v_mov_b32 v76, 0
    v_mov_b32 v77, 0
    v_mov_b32 v78, 0
    v_mov_b32 v79, 0
    v_mov_b32 v80, 0
    v_mov_b32 v81, 0
    v_mov_b32 v82, 0
    v_mov_b32 v83, 0
    v_mov_b32 v84, 0
    v_mov_b32 v85, 0
    v_mov_b32 v86, 0
    v_mov_b32 v87, 0
    v_mov_b32 v88, 0
    v_mov_b32 v89, 0
    v_mov_b32 v90, 0
    v_mov_b32 v91, 0
    v_mov_b32 v92, 0
    v_mov_b32 v93, 0
    v_mov_b32 v94, 0
    v_mov_b32 v95, 0
    v_mov_b32 v96, 0
    v_mov_b32 v97, 0
    v_mov_b32 v98, 0
    v_mov_b32 v99, 0
    v_mov_b32 v100, 0
    v_mov_b32 v101, 0
    v_mov_b32 v102, 0
    v_mov_b32 v103, 0
    s_waitcnt lgkmcnt(0)
    s_cmp_gt_i32 s28, 0
    s_cselect_b32 s56, -1, 0
    s_cselect_b32 s28, s28, 0x8000
    s_min_u32 s28, s28, 0x8000
    s_cmp_gt_i32 s29, 0
    s_cselect_b32 s57, -1, 0
    s_cselect_b32 s29, s29, 0x8000
    s_min_u32 s29, s29, 0x8000
    s_mov_b32 s53, 0
    s_cmp_gt_u32 s28, 16368
    s_cselect_b32 s70, s70, s88
    s_cselect_b32 s71, s71, s89
    s_cselect_b32 s72, s72, s90
    s_cselect_b32 s73, s73, s91
    s_cselect_b32 s74, s74, s92
    s_cselect_b32 s75, s75, s93
    s_cselect_b32 s76, s76, s94
    s_cselect_b32 s77, s77, s95
    s_cselect_b32 s40, s83, s31
    s_cselect_b32 s41, 32, 4
    s_cselect_b32 s42, 4, 8
    s_cselect_b32 s43, 36, 12
    s_lshl_b32 s50, s40, 4
    s_sub_i32 s51, s28, s50
    s_sub_i32 s52, s29, s50
    s_max_i32 s51, s51, 0
    s_max_i32 s52, s52, 0
    s_min_i32 s51, s51, 16
    s_min_i32 s52, s52, 16
    s_cmp_eq_u32 s70, s71
    s_cselect_b32 s52, s52, 0
    s_lshl_b32 s52, s52, 8
    s_or_b32 s52, s52, s51
    s_pack_ll_b32_b16 s34, s52, s70
    s_cmp_eq_u32 s51, 0
    s_cselect_b32 s34, 0x80000000, s34
    s_add_u32 s51, s83, 0
    s_lshl_b32 s51, s51, 16
    s_xor_b32 s51, s51, s34
    s_or_b32 s53, s53, s51
    s_lshl4_add_u32 s50, s41, s40
    s_lshl_b32 s50, s50, 4
    s_sub_i32 s51, s28, s50
    s_sub_i32 s52, s29, s50
    s_max_i32 s51, s51, 0
    s_max_i32 s52, s52, 0
    s_min_i32 s51, s51, 16
    s_min_i32 s52, s52, 16
    s_cmp_eq_u32 s72, s73
    s_cselect_b32 s52, s52, 0
    s_lshl_b32 s52, s52, 8
    s_or_b32 s52, s52, s51
    s_pack_ll_b32_b16 s36, s52, s72
    s_cmp_eq_u32 s51, 0
    s_cselect_b32 s36, 0x80000000, s36
    s_add_u32 s51, s83, 512
    s_lshl_b32 s51, s51, 16
    s_xor_b32 s51, s51, s36
    s_or_b32 s53, s53, s51
    s_lshl4_add_u32 s50, s42, s40
    s_lshl_b32 s50, s50, 4
    s_sub_i32 s51, s28, s50
    s_sub_i32 s52, s29, s50
    s_max_i32 s51, s51, 0
    s_max_i32 s52, s52, 0
    s_min_i32 s51, s51, 16
    s_min_i32 s52, s52, 16
    s_cmp_eq_u32 s74, s75
    s_cselect_b32 s52, s52, 0
    s_lshl_b32 s52, s52, 8
    s_or_b32 s52, s52, s51
    s_pack_ll_b32_b16 s35, s52, s74
    s_cmp_eq_u32 s51, 0
    s_cselect_b32 s35, 0x80000000, s35
    s_add_u32 s51, s83, 64
    s_lshl_b32 s51, s51, 16
    s_xor_b32 s51, s51, s35
    s_or_b32 s53, s53, s51
    s_lshl4_add_u32 s50, s43, s40
    s_lshl_b32 s50, s50, 4
    s_sub_i32 s51, s28, s50
    s_sub_i32 s52, s29, s50
    s_max_i32 s51, s51, 0
    s_max_i32 s52, s52, 0
    s_min_i32 s51, s51, 16
    s_min_i32 s52, s52, 16
    s_cmp_eq_u32 s76, s77
    s_cselect_b32 s52, s52, 0
    s_lshl_b32 s52, s52, 8
    s_or_b32 s52, s52, s51
    s_pack_ll_b32_b16 s37, s52, s76
    s_cmp_eq_u32 s51, 0
    s_cselect_b32 s37, 0x80000000, s37
    s_add_u32 s51, s83, 576
    s_lshl_b32 s51, s51, 16
    s_xor_b32 s51, s51, s37
    s_or_b32 s53, s53, s51
    s_cmp_lt_u32 s53, 0x10000
    s_cbranch_scc1 L_guessed
    s_waitcnt vmcnt(0)
    s_and_b32 s51, s34, 0xffff0000
    v_or_b32 v13, s51, v2
    s_and_b32 s51, s36, 0xffff0000
    v_or_b32 v14, s51, v2
    buffer_load_dwordx4 v[104:107], v13, s[20:23], s68 offen offset:0 nt
    buffer_load_dwordx4 v[108:111], v13, s[20:23], s68 offen offset:256 nt
    buffer_load_dwordx4 v[112:115], v13, s[20:23], s69 offen offset:0 nt
    buffer_load_dwordx4 v[116:119], v13, s[20:23], s69 offen offset:256 nt
    buffer_load_dwordx4 v[120:123], v14, s[24:27], s68 offen offset:0 nt
    buffer_load_dwordx4 v[124:127], v14, s[24:27], s68 offen offset:256 nt
    buffer_load_dwordx4 v[128:131], v14, s[24:27], s69 offen offset:0 nt
    buffer_load_dwordx4 v[132:135], v14, s[24:27], s69 offen offset:256 nt
    s_and_b32 s51, s35, 0xffff0000
    v_or_b32 v13, s51, v2
    s_and_b32 s51, s37, 0xffff0000
    v_or_b32 v14, s51, v2
    buffer_load_dwordx4 v[136:139], v13, s[20:23], s68 offen offset:0 nt
    buffer_load_dwordx4 v[140:143], v13, s[20:23], s68 offen offset:256 nt
    buffer_load_dwordx4 v[144:147], v13, s[20:23], s69 offen offset:0 nt
    buffer_load_dwordx4 v[148:151], v13, s[20:23], s69 offen offset:256 nt
    buffer_load_dwordx4 v[152:155], v14, s[24:27], s68 offen offset:0 nt
    buffer_load_dwordx4 v[156:159], v14, s[24:27], s68 offen offset:256 nt
    buffer_load_dwordx4 v[160:163], v14, s[24:27], s69 offen offset:0 nt
    buffer_load_dwordx4 v[164:167], v14, s[24:27], s69 offen offset:256 nt
L_guessed:
    s_or_b32 s34, s34, 0x20
    s_or_b32 s35, s35, 0x20
    v_mov_b32 v36, s34
    v_mov_b32 v37, s36
    v_mov_b32 v38, s35
    v_mov_b32 v39, s37
    v_mov_b32 v6, 24832
    ds_write_b128 v6, v[36:39] offset:32
    v_mov_b32 v61, s56
    v_mov_b32 v62, s57
    v_cmp_eq_u32 vcc, 0, v5
    s_nop 1
    v_cndmask_b32 v61, v62, v61, vcc
    s_waitcnt vmcnt(16) lgkmcnt(0)
    v_and_b32 v20, v61, v20
    v_and_b32 v21, v61, v21
    v_and_b32 v22, v61, v22
    v_and_b32 v23, v61, v23
    v_and_b32 v24, v61, v24
    v_and_b32 v25, v61, v25
    v_and_b32 v26, v61, v26
    v_and_b32 v27, v61, v27
    v_and_b32 v28, v61, v28
    v_and_b32 v29, v61, v29
    v_and_b32 v30, v61, v30
    v_and_b32 v31, v61, v31
    v_and_b32 v32, v61, v32
    v_and_b32 v33, v61, v33
    v_and_b32 v34, v61, v34
    v_and_b32 v35, v61, v35
L_head0:
    s_bitcmp0_b32 s38, 14
    s_cbranch_scc1 L_more0
    s_bitcmp1_b32 s34, 31
    s_cbranch_scc1 L_done
    s_branch L_go0
L_more0:
    s_barrier
    ds_read_b64 v[0:1], v6
    v_xor_b32 v6, 8, v6
    s_waitcnt lgkmcnt(0)
    v_readfirstlane_b32 s38, v0
    v_readfirstlane_b32 s39, v1
L_go0:
    v_bfe_u32 v0, s34, v5, 5
    v_bfe_u32 v1, s36, v5, 5
    s_mov_b32 s82, s34
    s_bitcmp1_b32 s38, 6
    s_cselect_b64 s[20:21], s[8:9], s[6:7]
    s_cselect_b64 s[44:45], 0, -1
    s_bitcmp1_b32 s38, 5
    s_cselect_b64 s[24:25], s[6:7], s[8:9]
    s_cselect_b64 s[46:47], -1, 0
    v_cmp_gt_u32 vcc, v0, v4
    v_cmp_gt_u32 s[48:49], v1, v4
    v_cndmask_b32 v13, v3, v2, s[44:45]
    v_cndmask_b32 v14, v3, v2, s[46:47]
    s_mov_b32 s34, s38
    s_mov_b32 s36, s39
    s_and_b32 s50, s38, 0xffff0000
    s_and_b32 s51, s39, 0xffff0000
    v_or_b32 v13, s50, v13
    v_or_b32 v14, s51, v14
    s_bitcmp0_b32 s82, 5
    s_cbranch_scc1 L_other0
    s_waitcnt vmcnt(14)
    v_mfma_f32_16x16x32_bf16 v[40:43], v[104:107], v[20:23], 0
    v_mfma_f32_16x16x32_bf16 v[40:43], v[108:111], v[24:27], v[40:43]
    buffer_load_dwordx4 v[104:107], v13, s[20:23], s68 offen offset:0 nt
    buffer_load_dwordx4 v[108:111], v13, s[20:23], s68 offen offset:256 nt
    s_waitcnt vmcnt(14)
    v_mfma_f32_16x16x32_bf16 v[44:47], v[112:115], v[28:31], 0
    v_mfma_f32_16x16x32_bf16 v[44:47], v[116:119], v[32:35], v[44:47]
    buffer_load_dwordx4 v[112:115], v13, s[20:23], s69 offen offset:0 nt
    buffer_load_dwordx4 v[116:119], v13, s[20:23], s69 offen offset:256 nt
    s_waitcnt vmcnt(14)
    v_mfma_f32_16x16x32_bf16 v[48:51], v[120:123], v[20:23], 0
    v_mfma_f32_16x16x32_bf16 v[48:51], v[124:127], v[24:27], v[48:51]
    buffer_load_dwordx4 v[120:123], v14, s[24:27], s68 offen offset:0 nt
    buffer_load_dwordx4 v[124:127], v14, s[24:27], s68 offen offset:256 nt
    s_waitcnt vmcnt(14)
    v_mfma_f32_16x16x32_bf16 v[52:55], v[128:131], v[28:31], 0
    v_mfma_f32_16x16x32_bf16 v[52:55], v[132:135], v[32:35], v[52:55]
    buffer_load_dwordx4 v[128:131], v14, s[24:27], s69 offen offset:0 nt
    buffer_load_dwordx4 v[132:135], v14, s[24:27], s69 offen offset:256 nt
    v_mov_b32_dpp v56, v40 quad_perm:[0,0,0,0] row_mask:0xf bank_mask:0xf
    v_mov_b32_dpp v57, v42 quad_perm:[2,2,2,2] row_mask:0xf bank_mask:0xf
    v_mov_b32_dpp v58, v44 quad_perm:[0,0,0,0] row_mask:0xf bank_mask:0xf
    v_mov_b32_dpp v59, v46 quad_perm:[2,2,2,2] row_mask:0xf bank_mask:0xf
    v_mov_b32_dpp v60, v48 quad_perm:[0,0,0,0] row_mask:0xf bank_mask:0xf
    v_mov_b32_dpp v61, v50 quad_perm:[2,2,2,2] row_mask:0xf bank_mask:0xf
    v_mov_b32_dpp v62, v52 quad_perm:[0,0,0,0] row_mask:0xf bank_mask:0xf
    v_mov_b32_dpp v63, v54 quad_perm:[2,2,2,2] row_mask:0xf bank_mask:0xf
    v_add_f32_dpp v56, v41, v56 quad_perm:[1,1,1,1] row_mask:0xf bank_mask:0xf
    v_add_f32_dpp v57, v43, v57 quad_perm:[3,3,3,3] row_mask:0xf bank_mask:0xf
    v_add_f32_dpp v58, v45, v58 quad_perm:[1,1,1,1] row_mask:0xf bank_mask:0xf
    v_add_f32_dpp v59, v47, v59 quad_perm:[3,3,3,3] row_mask:0xf bank_mask:0xf
    v_add_f32_dpp v60, v49, v60 quad_perm:[1,1,1,1] row_mask:0xf bank_mask:0xf
    v_add_f32_dpp v61, v51, v61 quad_perm:[3,3,3,3] row_mask:0xf bank_mask:0xf
    v_add_f32_dpp v62, v53, v62 quad_perm:[1,1,1,1] row_mask:0xf bank_mask:0xf
    v_add_f32_dpp v63, v55, v63 quad_perm:[3,3,3,3] row_mask:0xf bank_mask:0xf
    v_add_f32 v36, v56, v57
    v_add_f32 v37, v58, v59
    v_add_f32 v38, v60, v61
    v_add_f32 v39, v62, v63
    v_mul_f32 v36, s33, v36
    v_mul_f32 v37, s33, v37
    v_mul_f32 v38, s33, v38
    v_mul_f32 v39, s33, v39
    v_cndmask_b32 v36, v12, v36, vcc
    v_cndmask_b32 v37, v12, v37, vcc
    v_cndmask_b32 v38, v12, v38, s[48:49]
    v_cndmask_b32 v39, v12, v39, s[48:49]
    v_max3_f32 v8, v8, v36, v38
    v_max3_f32 v9, v9, v37, v39
    v_cndmask_b32 v36, v36, v37, s[78:79]
    v_cndmask_b32 v38, v38, v39, s[78:79]
    v_cndmask_b32 v36, v36, v38, s[80:81]
    ds_write_b32 v7, v36
    v_add_u32 v7, 0x400, v7
L_head1:
    s_bitcmp0_b32 s38, 14
    s_cbranch_scc1 L_more1
    s_bitcmp1_b32 s35, 31
    s_cbranch_scc1 L_done
    s_branch L_go1
L_more1:
    s_barrier
    ds_read_b64 v[0:1], v6
    v_xor_b32 v6, 8, v6
    s_waitcnt lgkmcnt(0)
    v_readfirstlane_b32 s38, v0
    v_readfirstlane_b32 s39, v1
L_go1:
    v_bfe_u32 v0, s35, v5, 5
    v_bfe_u32 v1, s37, v5, 5
    s_mov_b32 s82, s35
    s_bitcmp1_b32 s38, 6
    s_cselect_b64 s[20:21], s[8:9], s[6:7]
    s_cselect_b64 s[44:45], 0, -1
    s_bitcmp1_b32 s38, 5
    s_cselect_b64 s[24:25], s[6:7], s[8:9]
    s_cselect_b64 s[46:47], -1, 0
    v_cmp_gt_u32 vcc, v0, v4
    v_cmp_gt_u32 s[48:49], v1, v4
    v_cndmask_b32 v13, v3, v2, s[44:45]
    v_cndmask_b32 v14, v3, v2, s[46:47]
    s_mov_b32 s35, s38
    s_mov_b32 s37, s39
    s_and_b32 s50, s38, 0xffff0000
    s_and_b32 s51, s39, 0xffff0000
    v_or_b32 v13, s50, v13
    v_or_b32 v14, s51, v14
    s_bitcmp0_b32 s82, 5
    s_cbranch_scc1 L_other1
    s_waitcnt vmcnt(14)
    v_mfma_f32_16x16x32_bf16 v[40:43], v[136:139], v[20:23], 0
    v_mfma_f32_16x16x32_bf16 v[40:43], v[140:143], v[24:27], v[40:43]
    buffer_load_dwordx4 v[136:139], v13, s[20:23], s68 offen offset:0 nt
    buffer_load_dwordx4 v[140:143], v13, s[20:23], s68 offen offset:256 nt
    s_waitcnt vmcnt(14)
    v_mfma_f32_16x16x32_bf16 v[44:47], v[144:147], v[28:31], 0
    v_mfma_f32_16x16x32_bf16 v[44:47], v[148:151], v[32:35], v[44:47]
    buffer_load_dwordx4 v[144:147], v13, s[20:23], s69 offen offset:0 nt
    buffer_load_dwordx4 v[148:151], v13, s[20:23], s69 offen offset:256 nt
    s_waitcnt vmcnt(14)
    v_mfma_f32_16x16x32_bf16 v[48:51], v[152:155], v[20:23], 0
    v_mfma_f32_16x16x32_bf16 v[48:51], v[156:159], v[24:27], v[48:51]
    buffer_load_dwordx4 v[152:155], v14, s[24:27], s68 offen offset:0 nt
    buffer_load_dwordx4 v[156:159], v14, s[24:27], s68 offen offset:256 nt
    s_waitcnt vmcnt(14)
    v_mfma_f32_16x16x32_bf16 v[52:55], v[160:163], v[28:31], 0
    v_mfma_f32_16x16x32_bf16 v[52:55], v[164:167], v[32:35], v[52:55]
    buffer_load_dwordx4 v[160:163], v14, s[24:27], s69 offen offset:0 nt
    buffer_load_dwordx4 v[164:167], v14, s[24:27], s69 offen offset:256 nt
    v_mov_b32_dpp v56, v40 quad_perm:[0,0,0,0] row_mask:0xf bank_mask:0xf
    v_mov_b32_dpp v57, v42 quad_perm:[2,2,2,2] row_mask:0xf bank_mask:0xf
    v_mov_b32_dpp v58, v44 quad_perm:[0,0,0,0] row_mask:0xf bank_mask:0xf
    v_mov_b32_dpp v59, v46 quad_perm:[2,2,2,2] row_mask:0xf bank_mask:0xf
    v_mov_b32_dpp v60, v48 quad_perm:[0,0,0,0] row_mask:0xf bank_mask:0xf
    v_mov_b32_dpp v61, v50 quad_perm:[2,2,2,2] row_mask:0xf bank_mask:0xf
    v_mov_b32_dpp v62, v52 quad_perm:[0,0,0,0] row_mask:0xf bank_mask:0xf
    v_mov_b32_dpp v63, v54 quad_perm:[2,2,2,2] row_mask:0xf bank_mask:0xf
    v_add_f32_dpp v56, v41, v56 quad_perm:[1,1,1,1] row_mask:0xf bank_mask:0xf
    v_add_f32_dpp v57, v43, v57 quad_perm:[3,3,3,3] row_mask:0xf bank_mask:0xf
    v_add_f32_dpp v58, v45, v58 quad_perm:[1,1,1,1] row_mask:0xf bank_mask:0xf
    v_add_f32_dpp v59, v47, v59 quad_perm:[3,3,3,3] row_mask:0xf bank_mask:0xf
    v_add_f32_dpp v60, v49, v60 quad_perm:[1,1,1,1] row_mask:0xf bank_mask:0xf
    v_add_f32_dpp v61, v51, v61 quad_perm:[3,3,3,3] row_mask:0xf bank_mask:0xf
    v_add_f32_dpp v62, v53, v62 quad_perm:[1,1,1,1] row_mask:0xf bank_mask:0xf
    v_add_f32_dpp v63, v55, v63 quad_perm:[3,3,3,3] row_mask:0xf bank_mask:0xf
    v_add_f32 v36, v56, v57
    v_add_f32 v37, v58, v59
    v_add_f32 v38, v60, v61
    v_add_f32 v39, v62, v63
    v_mul_f32 v36, s33, v36
    v_mul_f32 v37, s33, v37
    v_mul_f32 v38, s33, v38
    v_mul_f32 v39, s33, v39
    v_cndmask_b32 v36, v12, v36, vcc
    v_cndmask_b32 v37, v12, v37, vcc
    v_cndmask_b32 v38, v12, v38, s[48:49]
    v_cndmask_b32 v39, v12, v39, s[48:49]
    v_max3_f32 v8, v8, v36, v38
    v_max3_f32 v9, v9, v37, v39
    v_cndmask_b32 v36, v36, v37, s[78:79]
    v_cndmask_b32 v38, v38, v39, s[78:79]
    v_cndmask_b32 v36, v36, v38, s[80:81]
    ds_write_b32 v7, v36
    v_add_u32 v7, 0x400, v7
    s_branch L_head0
L_other0:
    s_bitcmp0_b32 s82, 6
    s_cbranch_scc1 L_kv0
    s_cmp_lg_u32 s67, 0
    s_cbranch_scc1 L_vn0
    s_mov_b32 s67, 1
    v_mov_b32 v36, v8
    v_mov_b32 v37, v9
    s_nop 0
    v_permlane16_swap_b32 v8, v36
    v_permlane16_swap_b32 v9, v37
    v_max_f32 v8, v8, v36
    v_max_f32 v9, v9, v37
    v_mov_b32 v36, v8
    v_mov_b32 v37, v9
    s_nop 0
    v_permlane32_swap_b32 v8, v36
    v_permlane32_swap_b32 v9, v37
    v_max_f32 v8, v8, v36
    v_max_f32 v9, v9, v37
    s_lshl_b32 s52, s32, 8
    s_add_u32 s52, s52, 25088
    v_lshl_add_u32 v7, v15, 2, s52
L_vn0:
    ds_read_b32 v0, v7
    v_add_u32 v7, 0x400, v7
    s_waitcnt lgkmcnt(0)
    v_sub_f32_dpp v36, v0, v8 quad_perm:[0,0,0,0] row_mask:0xf bank_mask:0xf
    v_sub_f32_dpp v37, v0, v9 quad_perm:[1,1,1,1] row_mask:0xf bank_mask:0xf
    v_sub_f32_dpp v38, v0, v8 quad_perm:[2,2,2,2] row_mask:0xf bank_mask:0xf
    v_sub_f32_dpp v39, v0, v9 quad_perm:[3,3,3,3] row_mask:0xf bank_mask:0xf
    v_exp_f32 v36, v36
    v_exp_f32 v37, v37
    v_exp_f32 v38, v38
    v_exp_f32 v39, v39
    v_add_f32 v10, v10, v36
    v_add_f32 v11, v11, v37
    v_add_f32 v10, v10, v38
    v_add_f32 v11, v11, v39
    v_cvt_pk_bf16_f32 v36, v36, v36
    v_cvt_pk_bf16_f32 v37, v37, v37
    v_cvt_pk_bf16_f32 v38, v38, v38
    v_cvt_pk_bf16_f32 v39, v39, v39
    v_and_b32 v56, v36, v16
    v_and_b32 v57, v36, v17
    v_and_b32_dpp v58, v36, v18 row_shr:4 row_mask:0xf bank_mask:0xf bound_ctrl:0
    v_and_b32_dpp v59, v36, v19 row_shr:4 row_mask:0xf bank_mask:0xf bound_ctrl:0
    v_and_b32_dpp v60, v36, v16 row_shl:4 row_mask:0xf bank_mask:0xf bound_ctrl:0
    v_and_b32_dpp v61, v36, v17 row_shl:4 row_mask:0xf bank_mask:0xf bound_ctrl:0
    v_and_b32 v62, v36, v18
    v_and_b32 v63, v36, v19
    v_and_b32 v64, v37, v16
    v_and_b32 v65, v37, v17
    v_and_b32_dpp v66, v37, v18 row_shr:4 row_mask:0xf bank_mask:0xf bound_ctrl:0
    v_and_b32_dpp v67, v37, v19 row_shr:4 row_mask:0xf bank_mask:0xf bound_ctrl:0
    v_and_b32_dpp v68, v37, v16 row_shl:4 row_mask:0xf bank_mask:0xf bound_ctrl:0
    v_and_b32_dpp v69, v37, v17 row_shl:4 row_mask:0xf bank_mask:0xf bound_ctrl:0
    v_and_b32 v70, v37, v18
    v_and_b32 v71, v37, v19
    v_and_b32 v40, v38, v16
    v_and_b32 v41, v38, v17
    v_and_b32_dpp v42, v38, v18 row_shr:4 row_mask:0xf bank_mask:0xf bound_ctrl:0
    v_and_b32_dpp v43, v38, v19 row_shr:4 row_mask:0xf bank_mask:0xf bound_ctrl:0
    v_and_b32_dpp v44, v38, v16 row_shl:4 row_mask:0xf bank_mask:0xf bound_ctrl:0
    v_and_b32_dpp v45, v38, v17 row_shl:4 row_mask:0xf bank_mask:0xf bound_ctrl:0
    v_and_b32 v46, v38, v18
    v_and_b32 v47, v38, v19
    v_and_b32 v48, v39, v16
    v_and_b32 v49, v39, v17
    v_and_b32_dpp v50, v39, v18 row_shr:4 row_mask:0xf bank_mask:0xf bound_ctrl:0
    v_and_b32_dpp v51, v39, v19 row_shr:4 row_mask:0xf bank_mask:0xf bound_ctrl:0
    v_and_b32_dpp v52, v39, v16 row_shl:4 row_mask:0xf bank_mask:0xf bound_ctrl:0
    v_and_b32_dpp v53, v39, v17 row_shl:4 row_mask:0xf bank_mask:0xf bound_ctrl:0
    v_and_b32 v54, v39, v18
    v_and_b32 v55, v39, v19
    s_waitcnt vmcnt(14)
    v_mfma_f32_16x16x32_bf16 v[72:75], v[56:59], v[104:107], v[72:75]
    v_mfma_f32_16x16x32_bf16 v[76:79], v[56:59], v[108:111], v[76:79]
    v_mfma_f32_16x16x32_bf16 v[80:83], v[60:63], v[104:107], v[80:83]
    v_mfma_f32_16x16x32_bf16 v[84:87], v[60:63], v[108:111], v[84:87]
    buffer_load_dwordx4 v[104:107], v13, s[20:23], s68 offen offset:0 nt
    buffer_load_dwordx4 v[108:111], v13, s[20:23], s68 offen offset:256 nt
    s_waitcnt vmcnt(14)
    v_mfma_f32_16x16x32_bf16 v[88:91], v[64:67], v[112:115], v[88:91]
    v_mfma_f32_16x16x32_bf16 v[92:95], v[64:67], v[116:119], v[92:95]
    v_mfma_f32_16x16x32_bf16 v[96:99], v[68:71], v[112:115], v[96:99]
    v_mfma_f32_16x16x32_bf16 v[100:103], v[68:71], v[116:119], v[100:103]
    buffer_load_dwordx4 v[112:115], v13, s[20:23], s69 offen offset:0 nt
    buffer_load_dwordx4 v[116:119], v13, s[20:23], s69 offen offset:256 nt
    s_waitcnt vmcnt(14)
    v_mfma_f32_16x16x32_bf16 v[72:75], v[40:43], v[120:123], v[72:75]
    v_mfma_f32_16x16x32_bf16 v[76:79], v[40:43], v[124:127], v[76:79]
    v_mfma_f32_16x16x32_bf16 v[80:83], v[44:47], v[120:123], v[80:83]
    v_mfma_f32_16x16x32_bf16 v[84:87], v[44:47], v[124:127], v[84:87]
    buffer_load_dwordx4 v[120:123], v14, s[24:27], s68 offen offset:0 nt
    buffer_load_dwordx4 v[124:127], v14, s[24:27], s68 offen offset:256 nt
    s_waitcnt vmcnt(14)
    v_mfma_f32_16x16x32_bf16 v[88:91], v[48:51], v[128:131], v[88:91]
    v_mfma_f32_16x16x32_bf16 v[92:95], v[48:51], v[132:135], v[92:95]
    v_mfma_f32_16x16x32_bf16 v[96:99], v[52:55], v[128:131], v[96:99]
    v_mfma_f32_16x16x32_bf16 v[100:103], v[52:55], v[132:135], v[100:103]
    buffer_load_dwordx4 v[128:131], v14, s[24:27], s69 offen offset:0 nt
    buffer_load_dwordx4 v[132:135], v14, s[24:27], s69 offen offset:256 nt
    s_branch L_head1
L_other1:
    s_bitcmp0_b32 s82, 6
    s_cbranch_scc1 L_kv1
    s_cmp_lg_u32 s67, 0
    s_cbranch_scc1 L_vn1
    s_mov_b32 s67, 1
    v_mov_b32 v36, v8
    v_mov_b32 v37, v9
    s_nop 0
    v_permlane16_swap_b32 v8, v36
    v_permlane16_swap_b32 v9, v37
    v_max_f32 v8, v8, v36
    v_max_f32 v9, v9, v37
    v_mov_b32 v36, v8
    v_mov_b32 v37, v9
    s_nop 0
    v_permlane32_swap_b32 v8, v36
    v_permlane32_swap_b32 v9, v37
    v_max_f32 v8, v8, v36
    v_max_f32 v9, v9, v37
    s_lshl_b32 s52, s32, 8
    s_add_u32 s52, s52, 25088
    v_lshl_add_u32 v7, v15, 2, s52
L_vn1:
    ds_read_b32 v0, v7
    v_add_u32 v7, 0x400, v7
    s_waitcnt lgkmcnt(0)
    v_sub_f32_dpp v36, v0, v8 quad_perm:[0,0,0,0] row_mask:0xf bank_mask:0xf
    v_sub_f32_dpp v37, v0, v9 quad_perm:[1,1,1,1] row_mask:0xf bank_mask:0xf
    v_sub_f32_dpp v38, v0, v8 quad_perm:[2,2,2,2] row_mask:0xf bank_mask:0xf
    v_sub_f32_dpp v39, v0, v9 quad_perm:[3,3,3,3] row_mask:0xf bank_mask:0xf
    v_exp_f32 v36, v36
    v_exp_f32 v37, v37
    v_exp_f32 v38, v38
    v_exp_f32 v39, v39
    v_add_f32 v10, v10, v36
    v_add_f32 v11, v11, v37
    v_add_f32 v10, v10, v38
    v_add_f32 v11, v11, v39
    v_cvt_pk_bf16_f32 v36, v36, v36
    v_cvt_pk_bf16_f32 v37, v37, v37
    v_cvt_pk_bf16_f32 v38, v38, v38
    v_cvt_pk_bf16_f32 v39, v39, v39
    v_and_b32 v56, v36, v16
    v_and_b32 v57, v36, v17
    v_and_b32_dpp v58, v36, v18 row_shr:4 row_mask:0xf bank_mask:0xf bound_ctrl:0
    v_and_b32_dpp v59, v36, v19 row_shr:4 row_mask:0xf bank_mask:0xf bound_ctrl:0
    v_and_b32_dpp v60, v36, v16 row_shl:4 row_mask:0xf bank_mask:0xf bound_ctrl:0
    v_and_b32_dpp v61, v36, v17 row_shl:4 row_mask:0xf bank_mask:0xf bound_ctrl:0
    v_and_b32 v62, v36, v18
    v_and_b32 v63, v36, v19
    v_and_b32 v64, v37, v16
    v_and_b32 v65, v37, v17
    v_and_b32_dpp v66, v37, v18 row_shr:4 row_mask:0xf bank_mask:0xf bound_ctrl:0
    v_and_b32_dpp v67, v37, v19 row_shr:4 row_mask:0xf bank_mask:0xf bound_ctrl:0
    v_and_b32_dpp v68, v37, v16 row_shl:4 row_mask:0xf bank_mask:0xf bound_ctrl:0
    v_and_b32_dpp v69, v37, v17 row_shl:4 row_mask:0xf bank_mask:0xf bound_ctrl:0
    v_and_b32 v70, v37, v18
    v_and_b32 v71, v37, v19
    v_and_b32 v40, v38, v16
    v_and_b32 v41, v38, v17
    v_and_b32_dpp v42, v38, v18 row_shr:4 row_mask:0xf bank_mask:0xf bound_ctrl:0
    v_and_b32_dpp v43, v38, v19 row_shr:4 row_mask:0xf bank_mask:0xf bound_ctrl:0
    v_and_b32_dpp v44, v38, v16 row_shl:4 row_mask:0xf bank_mask:0xf bound_ctrl:0
    v_and_b32_dpp v45, v38, v17 row_shl:4 row_mask:0xf bank_mask:0xf bound_ctrl:0
    v_and_b32 v46, v38, v18
    v_and_b32 v47, v38, v19
    v_and_b32 v48, v39, v16
    v_and_b32 v49, v39, v17
    v_and_b32_dpp v50, v39, v18 row_shr:4 row_mask:0xf bank_mask:0xf bound_ctrl:0
    v_and_b32_dpp v51, v39, v19 row_shr:4 row_mask:0xf bank_mask:0xf bound_ctrl:0
    v_and_b32_dpp v52, v39, v16 row_shl:4 row_mask:0xf bank_mask:0xf bound_ctrl:0
    v_and_b32_dpp v53, v39, v17 row_shl:4 row_mask:0xf bank_mask:0xf bound_ctrl:0
    v_and_b32 v54, v39, v18
    v_and_b32 v55, v39, v19
    s_waitcnt vmcnt(14)
    v_mfma_f32_16x16x32_bf16 v[72:75], v[56:59], v[136:139], v[72:75]
    v_mfma_f32_16x16x32_bf16 v[76:79], v[56:59], v[140:143], v[76:79]
    v_mfma_f32_16x16x32_bf16 v[80:83], v[60:63], v[136:139], v[80:83]
    v_mfma_f32_16x16x32_bf16 v[84:87], v[60:63], v[140:143], v[84:87]
    buffer_load_dwordx4 v[136:139], v13, s[20:23], s68 offen offset:0 nt
    buffer_load_dwordx4 v[140:143], v13, s[20:23], s68 offen offset:256 nt
    s_waitcnt vmcnt(14)
    v_mfma_f32_16x16x32_bf16 v[88:91], v[64:67], v[144:147], v[88:91]
    v_mfma_f32_16x16x32_bf16 v[92:95], v[64:67], v[148:151], v[92:95]
    v_mfma_f32_16x16x32_bf16 v[96:99], v[68:71], v[144:147], v[96:99]
    v_mfma_f32_16x16x32_bf16 v[100:103], v[68:71], v[148:151], v[100:103]
    buffer_load_dwordx4 v[144:147], v13, s[20:23], s69 offen offset:0 nt
    buffer_load_dwordx4 v[148:151], v13, s[20:23], s69 offen offset:256 nt
    s_waitcnt vmcnt(14)
    v_mfma_f32_16x16x32_bf16 v[72:75], v[40:43], v[152:155], v[72:75]
    v_mfma_f32_16x16x32_bf16 v[76:79], v[40:43], v[156:159], v[76:79]
    v_mfma_f32_16x16x32_bf16 v[80:83], v[44:47], v[152:155], v[80:83]
    v_mfma_f32_16x16x32_bf16 v[84:87], v[44:47], v[156:159], v[84:87]
    buffer_load_dwordx4 v[152:155], v14, s[24:27], s68 offen offset:0 nt
    buffer_load_dwordx4 v[156:159], v14, s[24:27], s68 offen offset:256 nt
    s_waitcnt vmcnt(14)
    v_mfma_f32_16x16x32_bf16 v[88:91], v[48:51], v[160:163], v[88:91]
    v_mfma_f32_16x16x32_bf16 v[92:95], v[48:51], v[164:167], v[92:95]
    v_mfma_f32_16x16x32_bf16 v[96:99], v[52:55], v[160:163], v[96:99]
    v_mfma_f32_16x16x32_bf16 v[100:103], v[52:55], v[164:167], v[100:103]
    buffer_load_dwordx4 v[160:163], v14, s[24:27], s69 offen offset:0 nt
    buffer_load_dwordx4 v[164:167], v14, s[24:27], s69 offen offset:256 nt
    s_branch L_head0
L_kv0:
    s_waitcnt vmcnt(14)
    v_mfma_f32_16x16x32_bf16 v[40:43], v[104:107], v[20:23], 0
    v_mfma_f32_16x16x32_bf16 v[40:43], v[108:111], v[24:27], v[40:43]
    buffer_load_dwordx4 v[104:107], v13, s[20:23], s68 offen offset:0 nt
    buffer_load_dwordx4 v[108:111], v13, s[20:23], s68 offen offset:256 nt
    s_waitcnt vmcnt(14)
    v_mfma_f32_16x16x32_bf16 v[44:47], v[112:115], v[28:31], 0
    v_mfma_f32_16x16x32_bf16 v[44:47], v[116:119], v[32:35], v[44:47]
    buffer_load_dwordx4 v[112:115], v13, s[20:23], s69 offen offset:0 nt
    buffer_load_dwordx4 v[116:119], v13, s[20:23], s69 offen offset:256 nt
    s_nop 3
    v_mov_b32_dpp v36, v40 quad_perm:[0,0,0,0] row_mask:0xf bank_mask:0xf
    v_mov_b32_dpp v37, v42 quad_perm:[2,2,2,2] row_mask:0xf bank_mask:0xf
    v_mov_b32_dpp v38, v44 quad_perm:[0,0,0,0] row_mask:0xf bank_mask:0xf
    v_mov_b32_dpp v39, v46 quad_perm:[2,2,2,2] row_mask:0xf bank_mask:0xf
    v_add_f32_dpp v36, v41, v36 quad_perm:[1,1,1,1] row_mask:0xf bank_mask:0xf
    v_add_f32_dpp v37, v43, v37 quad_perm:[3,3,3,3] row_mask:0xf bank_mask:0xf
    v_add_f32_dpp v38, v45, v38 quad_perm:[1,1,1,1] row_mask:0xf bank_mask:0xf
    v_add_f32_dpp v39, v47, v39 quad_perm:[3,3,3,3] row_mask:0xf bank_mask:0xf
    v_add_f32 v36, v36, v37
    v_add_f32 v38, v38, v39
    v_mul_f32 v36, s33, v36
    v_mul_f32 v38, s33, v38
    v_cndmask_b32 v36, v12, v36, vcc
    v_cndmask_b32 v38, v12, v38, vcc
    v_max_f32 v48, v36, v8
    v_max_f32 v49, v38, v9
    v_mov_b32 v50, v48
    v_mov_b32 v51, v49
    s_nop 0
    v_permlane16_swap_b32 v48, v50
    v_permlane16_swap_b32 v49, v51
    v_max_f32 v48, v48, v50
    v_max_f32 v49, v49, v51
    v_mov_b32 v50, v48
    v_mov_b32 v51, v49
    s_nop 0
    v_permlane32_swap_b32 v48, v50
    v_permlane32_swap_b32 v49, v51
    v_max_f32 v48, v48, v50
    v_max_f32 v49, v49, v51
    v_sub_f32 v50, v8, v48
    v_sub_f32 v51, v9, v49
    v_sub_f32 v36, v36, v48
    v_sub_f32 v38, v38, v49
    v_exp_f32 v50, v50
    v_exp_f32 v51, v51
    v_exp_f32 v36, v36
    v_exp_f32 v38, v38
    v_mov_b32 v8, v48
    v_mov_b32 v9, v49
    v_mov_b32_dpp v52, v50 row_newbcast:0 row_mask:0x3 bank_mask:0xf
    v_mov_b32_dpp v53, v50 row_newbcast:4 row_mask:0x3 bank_mask:0xf
    v_mov_b32_dpp v54, v51 row_newbcast:0 row_mask:0x3 bank_mask:0xf
    v_mov_b32_dpp v55, v51 row_newbcast:4 row_mask:0x3 bank_mask:0xf
    v_mov_b32_dpp v52, v50 row_newbcast:8 row_mask:0xc bank_mask:0xf
    v_mov_b32_dpp v53, v50 row_newbcast:12 row_mask:0xc bank_mask:0xf
    v_mov_b32_dpp v54, v51 row_newbcast:8 row_mask:0xc bank_mask:0xf
    v_mov_b32_dpp v55, v51 row_newbcast:12 row_mask:0xc bank_mask:0xf
    v_cvt_pk_bf16_f32 v37, v36, v36
    v_cvt_pk_bf16_f32 v39, v38, v38
    v_fma_f32 v10, v10, v50, v36
    v_fma_f32 v11, v11, v51, v38
    v_and_b32 v56, v37, v16
    v_and_b32 v57, v37, v17
    v_and_b32_dpp v58, v37, v18 row_shr:4 row_mask:0xf bank_mask:0xf bound_ctrl:0
    v_and_b32_dpp v59, v37, v19 row_shr:4 row_mask:0xf bank_mask:0xf bound_ctrl:0
    v_and_b32_dpp v60, v37, v16 row_shl:4 row_mask:0xf bank_mask:0xf bound_ctrl:0
    v_and_b32_dpp v61, v37, v17 row_shl:4 row_mask:0xf bank_mask:0xf bound_ctrl:0
    v_and_b32 v62, v37, v18
    v_and_b32 v63, v37, v19
    v_and_b32 v64, v39, v16
    v_and_b32 v65, v39, v17
    v_and_b32_dpp v66, v39, v18 row_shr:4 row_mask:0xf bank_mask:0xf bound_ctrl:0
    v_and_b32_dpp v67, v39, v19 row_shr:4 row_mask:0xf bank_mask:0xf bound_ctrl:0
    v_and_b32_dpp v68, v39, v16 row_shl:4 row_mask:0xf bank_mask:0xf bound_ctrl:0
    v_and_b32_dpp v69, v39, v17 row_shl:4 row_mask:0xf bank_mask:0xf bound_ctrl:0
    v_and_b32 v70, v39, v18
    v_and_b32 v71, v39, v19
    v_mul_f32 v72, v52, v72
    v_mul_f32 v73, v52, v73
    v_mul_f32 v74, v52, v74
    v_mul_f32 v75, v52, v75
    v_mul_f32 v76, v52, v76
    v_mul_f32 v77, v52, v77
    v_mul_f32 v78, v52, v78
    v_mul_f32 v79, v52, v79
    v_mul_f32 v80, v53, v80
    v_mul_f32 v81, v53, v81
    v_mul_f32 v82, v53, v82
    v_mul_f32 v83, v53, v83
    v_mul_f32 v84, v53, v84
    v_mul_f32 v85, v53, v85
    v_mul_f32 v86, v53, v86
    v_mul_f32 v87, v53, v87
    v_mul_f32 v88, v54, v88
    v_mul_f32 v89, v54, v89
    v_mul_f32 v90, v54, v90
    v_mul_f32 v91, v54, v91
    v_mul_f32 v92, v54, v92
    v_mul_f32 v93, v54, v93
    v_mul_f32 v94, v54, v94
    v_mul_f32 v95, v54, v95
    v_mul_f32 v96, v55, v96
    v_mul_f32 v97, v55, v97
    v_mul_f32 v98, v55, v98
    v_mul_f32 v99, v55, v99
    v_mul_f32 v100, v55, v100
    v_mul_f32 v101, v55, v101
    v_mul_f32 v102, v55, v102
    v_mul_f32 v103, v55, v103
    s_nop 0
    s_waitcnt vmcnt(14)
    v_mfma_f32_16x16x32_bf16 v[72:75], v[56:59], v[120:123], v[72:75]
    v_mfma_f32_16x16x32_bf16 v[76:79], v[56:59], v[124:127], v[76:79]
    v_mfma_f32_16x16x32_bf16 v[80:83], v[60:63], v[120:123], v[80:83]
    v_mfma_f32_16x16x32_bf16 v[84:87], v[60:63], v[124:127], v[84:87]
    buffer_load_dwordx4 v[120:123], v14, s[24:27], s68 offen offset:0 nt
    buffer_load_dwordx4 v[124:127], v14, s[24:27], s68 offen offset:256 nt
    s_waitcnt vmcnt(14)
    v_mfma_f32_16x16x32_bf16 v[88:91], v[64:67], v[128:131], v[88:91]
    v_mfma_f32_16x16x32_bf16 v[92:95], v[64:67], v[132:135], v[92:95]
    v_mfma_f32_16x16x32_bf16 v[96:99], v[68:71], v[128:131], v[96:99]
    v_mfma_f32_16x16x32_bf16 v[100:103], v[68:71], v[132:135], v[100:103]
    buffer_load_dwordx4 v[128:131], v14, s[24:27], s69 offen offset:0 nt
    buffer_load_dwordx4 v[132:135], v14, s[24:27], s69 offen offset:256 nt
    s_branch L_head1
L_kv1:
    s_waitcnt vmcnt(14)
    v_mfma_f32_16x16x32_bf16 v[40:43], v[136:139], v[20:23], 0
    v_mfma_f32_16x16x32_bf16 v[40:43], v[140:143], v[24:27], v[40:43]
    buffer_load_dwordx4 v[136:139], v13, s[20:23], s68 offen offset:0 nt
    buffer_load_dwordx4 v[140:143], v13, s[20:23], s68 offen offset:256 nt
    s_waitcnt vmcnt(14)
    v_mfma_f32_16x16x32_bf16 v[44:47], v[144:147], v[28:31], 0
    v_mfma_f32_16x16x32_bf16 v[44:47], v[148:151], v[32:35], v[44:47]
    buffer_load_dwordx4 v[144:147], v13, s[20:23], s69 offen offset:0 nt
    buffer_load_dwordx4 v[148:151], v13, s[20:23], s69 offen offset:256 nt
    s_nop 3
    v_mov_b32_dpp v36, v40 quad_perm:[0,0,0,0] row_mask:0xf bank_mask:0xf
    v_mov_b32_dpp v37, v42 quad_perm:[2,2,2,2] row_mask:0xf bank_mask:0xf
    v_mov_b32_dpp v38, v44 quad_perm:[0,0,0,0] row_mask:0xf bank_mask:0xf
    v_mov_b32_dpp v39, v46 quad_perm:[2,2,2,2] row_mask:0xf bank_mask:0xf
    v_add_f32_dpp v36, v41, v36 quad_perm:[1,1,1,1] row_mask:0xf bank_mask:0xf
    v_add_f32_dpp v37, v43, v37 quad_perm:[3,3,3,3] row_mask:0xf bank_mask:0xf
    v_add_f32_dpp v38, v45, v38 quad_perm:[1,1,1,1] row_mask:0xf bank_mask:0xf
    v_add_f32_dpp v39, v47, v39 quad_perm:[3,3,3,3] row_mask:0xf bank_mask:0xf
    v_add_f32 v36, v36, v37
    v_add_f32 v38, v38, v39
    v_mul_f32 v36, s33, v36
    v_mul_f32 v38, s33, v38
    v_cndmask_b32 v36, v12, v36, vcc
    v_cndmask_b32 v38, v12, v38, vcc
    v_max_f32 v48, v36, v8
    v_max_f32 v49, v38, v9
    v_mov_b32 v50, v48
    v_mov_b32 v51, v49
    s_nop 0
    v_permlane16_swap_b32 v48, v50
    v_permlane16_swap_b32 v49, v51
    v_max_f32 v48, v48, v50
    v_max_f32 v49, v49, v51
    v_mov_b32 v50, v48
    v_mov_b32 v51, v49
    s_nop 0
    v_permlane32_swap_b32 v48, v50
    v_permlane32_swap_b32 v49, v51
    v_max_f32 v48, v48, v50
    v_max_f32 v49, v49, v51
    v_sub_f32 v50, v8, v48
    v_sub_f32 v51, v9, v49
    v_sub_f32 v36, v36, v48
    v_sub_f32 v38, v38, v49
    v_exp_f32 v50, v50
    v_exp_f32 v51, v51
    v_exp_f32 v36, v36
    v_exp_f32 v38, v38
    v_mov_b32 v8, v48
    v_mov_b32 v9, v49
    v_mov_b32_dpp v52, v50 row_newbcast:0 row_mask:0x3 bank_mask:0xf
    v_mov_b32_dpp v53, v50 row_newbcast:4 row_mask:0x3 bank_mask:0xf
    v_mov_b32_dpp v54, v51 row_newbcast:0 row_mask:0x3 bank_mask:0xf
    v_mov_b32_dpp v55, v51 row_newbcast:4 row_mask:0x3 bank_mask:0xf
    v_mov_b32_dpp v52, v50 row_newbcast:8 row_mask:0xc bank_mask:0xf
    v_mov_b32_dpp v53, v50 row_newbcast:12 row_mask:0xc bank_mask:0xf
    v_mov_b32_dpp v54, v51 row_newbcast:8 row_mask:0xc bank_mask:0xf
    v_mov_b32_dpp v55, v51 row_newbcast:12 row_mask:0xc bank_mask:0xf
    v_cvt_pk_bf16_f32 v37, v36, v36
    v_cvt_pk_bf16_f32 v39, v38, v38
    v_fma_f32 v10, v10, v50, v36
    v_fma_f32 v11, v11, v51, v38
    v_and_b32 v56, v37, v16
    v_and_b32 v57, v37, v17
    v_and_b32_dpp v58, v37, v18 row_shr:4 row_mask:0xf bank_mask:0xf bound_ctrl:0
    v_and_b32_dpp v59, v37, v19 row_shr:4 row_mask:0xf bank_mask:0xf bound_ctrl:0
    v_and_b32_dpp v60, v37, v16 row_shl:4 row_mask:0xf bank_mask:0xf bound_ctrl:0
    v_and_b32_dpp v61, v37, v17 row_shl:4 row_mask:0xf bank_mask:0xf bound_ctrl:0
    v_and_b32 v62, v37, v18
    v_and_b32 v63, v37, v19
    v_and_b32 v64, v39, v16
    v_and_b32 v65, v39, v17
    v_and_b32_dpp v66, v39, v18 row_shr:4 row_mask:0xf bank_mask:0xf bound_ctrl:0
    v_and_b32_dpp v67, v39, v19 row_shr:4 row_mask:0xf bank_mask:0xf bound_ctrl:0
    v_and_b32_dpp v68, v39, v16 row_shl:4 row_mask:0xf bank_mask:0xf bound_ctrl:0
    v_and_b32_dpp v69, v39, v17 row_shl:4 row_mask:0xf bank_mask:0xf bound_ctrl:0
    v_and_b32 v70, v39, v18
    v_and_b32 v71, v39, v19
    v_mul_f32 v72, v52, v72
    v_mul_f32 v73, v52, v73
    v_mul_f32 v74, v52, v74
    v_mul_f32 v75, v52, v75
    v_mul_f32 v76, v52, v76
    v_mul_f32 v77, v52, v77
    v_mul_f32 v78, v52, v78
    v_mul_f32 v79, v52, v79
    v_mul_f32 v80, v53, v80
    v_mul_f32 v81, v53, v81
    v_mul_f32 v82, v53, v82
    v_mul_f32 v83, v53, v83
    v_mul_f32 v84, v53, v84
    v_mul_f32 v85, v53, v85
    v_mul_f32 v86, v53, v86
    v_mul_f32 v87, v53, v87
    v_mul_f32 v88, v54, v88
    v_mul_f32 v89, v54, v89
    v_mul_f32 v90, v54, v90
    v_mul_f32 v91, v54, v91
    v_mul_f32 v92, v54, v92
    v_mul_f32 v93, v54, v93
    v_mul_f32 v94, v54, v94
    v_mul_f32 v95, v54, v95
    v_mul_f32 v96, v55, v96
    v_mul_f32 v97, v55, v97
    v_mul_f32 v98, v55, v98
    v_mul_f32 v99, v55, v99
    v_mul_f32 v100, v55, v100
    v_mul_f32 v101, v55, v101
    v_mul_f32 v102, v55, v102
    v_mul_f32 v103, v55, v103
    s_nop 0
    s_waitcnt vmcnt(14)
    v_mfma_f32_16x16x32_bf16 v[72:75], v[56:59], v[152:155], v[72:75]
    v_mfma_f32_16x16x32_bf16 v[76:79], v[56:59], v[156:159], v[76:79]
    v_mfma_f32_16x16x32_bf16 v[80:83], v[60:63], v[152:155], v[80:83]
    v_mfma_f32_16x16x32_bf16 v[84:87], v[60:63], v[156:159], v[84:87]
    buffer_load_dwordx4 v[152:155], v14, s[24:27], s68 offen offset:0 nt
    buffer_load_dwordx4 v[156:159], v14, s[24:27], s68 offen offset:256 nt
    s_waitcnt vmcnt(14)
    v_mfma_f32_16x16x32_bf16 v[88:91], v[64:67], v[160:163], v[88:91]
    v_mfma_f32_16x16x32_bf16 v[92:95], v[64:67], v[164:167], v[92:95]
    v_mfma_f32_16x16x32_bf16 v[96:99], v[68:71], v[160:163], v[96:99]
    v_mfma_f32_16x16x32_bf16 v[100:103], v[68:71], v[164:167], v[100:103]
    buffer_load_dwordx4 v[160:163], v14, s[24:27], s69 offen offset:0 nt
    buffer_load_dwordx4 v[164:167], v14, s[24:27], s69 offen offset:256 nt
    s_branch L_head0
L_done:
    v_lshlrev_b32 v56, 4, v15
    s_xor_b32 s50, s32, 1
    s_mul_i32 s50, s50, 6144
    v_add_u32 v57, s50, v56
    ds_write_b128 v57, v[80:83] offset:0
    ds_write_b128 v57, v[84:87] offset:1024
    s_xor_b32 s50, s32, 2
    s_mul_i32 s50, s50, 6144
    v_add_u32 v58, s50, v56
    ds_write_b128 v58, v[88:91] offset:2048
    ds_write_b128 v58, v[92:95] offset:3072
    s_xor_b32 s50, s32, 3
    s_mul_i32 s50, s50, 6144
    v_add_u32 v59, s50, v56
    ds_write_b128 v59, v[96:99] offset:4096
    ds_write_b128 v59, v[100:103] offset:5120
    v_mov_b32 v50, v10
    v_mov_b32 v51, v11
    s_nop 0
    v_permlane16_swap_b32 v10, v50
    v_permlane16_swap_b32 v11, v51
    v_add_f32 v10, v10, v50
    v_add_f32 v11, v11, v51
    v_mov_b32 v50, v10
    v_mov_b32 v51, v11
    s_nop 0
    v_permlane32_swap_b32 v10, v50
    v_permlane32_swap_b32 v11, v51
    v_add_f32 v41, v10, v50
    v_add_f32 v43, v11, v51
    v_mov_b32 v40, v8
    v_mov_b32 v42, v9
    v_bfe_u32 v60, v15, 2, 1
    v_xor_b32 v61, s32, v60
    v_lshlrev_b32 v61, 6, v61
    v_lshl_add_u32 v61, v60, 4, v61
    v_and_or_b32 v61, v15, 8, v61
    v_xor_b32 v60, 0x80, v61
    ds_write_b64 v61, v[40:41] offset:24576
    ds_write_b64 v60, v[42:43] offset:24608
    s_mul_i32 s50, s32, 6144
    v_add_u32 v56, s50, v56
    v_lshrrev_b32 v57, 5, v15
    s_lshl_b32 s50, s32, 6
    v_lshl_add_u32 v58, v57, 3, s50
    s_and_b32 s50, s32, 1
    s_lshl1_add_u32 s50, s3, s50
    s_lshl_b32 s50, s50, 10
    s_add_u32 s50, s50, s31
    v_lshl_add_u32 v57, v57, 9, s50
    v_bfe_u32 v59, v15, 2, 2
    v_lshl_add_u32 v57, v59, 6, v57
    v_bfe_u32 v59, v15, 4, 1
    v_and_b32 v62, 3, v15
    v_lshl_add_u32 v62, v59, 2, v62
    v_lshlrev_b32 v62, 4, v62
    v_lshl_add_u32 v62, v57, 7, v62
    v_add_u32 v63, 0x8000, v62
    s_lshl_b32 s50, s30, 6
    s_add_u32 s50, s50, s31
    s_lshl2_add_u32 s50, s50, s32
    s_lshl_b32 s50, s50, 6
    s_add_u32 s50, s50, 0x200000
    v_lshl_add_u32 v57, v15, 4, s50
    s_mov_b64 s[48:49], 15
    s_mov_b32 s40, 0x07060500
    s_mov_b32 s41, 0x07060501
    s_mov_b32 s42, 0x07060502
    s_mov_b32 s43, 0x07060503
    v_mov_b32 v59, 24832
    s_waitcnt lgkmcnt(0)
    s_barrier
    ds_read_b64 v[40:41], v58 offset:24576
    ds_read_b64 v[42:43], v58 offset:24592
    ds_read_b64 v[44:45], v58 offset:24608
    ds_read_b64 v[46:47], v58 offset:24624
    ds_read_b32 v66, v59 offset:16
    ds_read_b128 v[80:83], v56 offset:0
    ds_read_b128 v[84:87], v56 offset:1024
    ds_read_b128 v[88:91], v56 offset:2048
    ds_read_b128 v[92:95], v56 offset:3072
    ds_read_b128 v[96:99], v56 offset:4096
    ds_read_b128 v[100:103], v56 offset:5120
    s_waitcnt lgkmcnt(6)
    v_max3_f32 v64, v40, v42, v44
    v_max_f32 v64, v64, v46
    v_sub_f32 v40, v40, v64
    v_sub_f32 v42, v42, v64
    v_sub_f32 v44, v44, v64
    v_sub_f32 v46, v46, v64
    v_exp_f32 v40, v40
    v_exp_f32 v42, v42
    v_exp_f32 v44, v44
    v_exp_f32 v46, v46
    v_mul_f32 v72, v40, v72
    v_mul_f32 v73, v40, v73
    v_mul_f32 v74, v40, v74
    v_mul_f32 v75, v40, v75
    v_mul_f32 v76, v40, v76
    v_mul_f32 v77, v40, v77
    v_mul_f32 v78, v40, v78
    v_mul_f32 v79, v40, v79
    v_mul_f32 v65, v40, v41
    v_fmac_f32 v65, v42, v43
    v_fmac_f32 v65, v44, v45
    v_fmac_f32 v65, v46, v47
    v_mov_b32 v68, v64
    v_mov_b32 v69, v65
    s_nop 0
    v_permlane32_swap_b32 v64, v68
    v_permlane32_swap_b32 v65, v69
    v_cndmask_b32 v64, v64, v68, s[80:81]
    v_cndmask_b32 v65, v65, v69, s[80:81]
    s_waitcnt lgkmcnt(4)
    v_fmac_f32 v72, v42, v80
    v_fmac_f32 v73, v42, v81
    v_fmac_f32 v74, v42, v82
    v_fmac_f32 v75, v42, v83
    v_fmac_f32 v76, v42, v84
    v_fmac_f32 v77, v42, v85
    v_fmac_f32 v78, v42, v86
    v_fmac_f32 v79, v42, v87
    s_waitcnt lgkmcnt(2)
    v_fmac_f32 v72, v44, v88
    v_fmac_f32 v73, v44, v89
    v_fmac_f32 v74, v44, v90
    v_fmac_f32 v75, v44, v91
    v_fmac_f32 v76, v44, v92
    v_fmac_f32 v77, v44, v93
    v_fmac_f32 v78, v44, v94
    v_fmac_f32 v79, v44, v95
    s_waitcnt lgkmcnt(1)
    v_fmac_f32 v72, v46, v96
    v_fmac_f32 v73, v46, v97
    v_fmac_f32 v74, v46, v98
    v_fmac_f32 v75, v46, v99
    v_perm_b32 v72, v72, v66, s40
    v_perm_b32 v73, v73, v66, s41
    v_perm_b32 v74, v74, v66, s42
    v_perm_b32 v75, v75, v66, s43
    global_store_dwordx4 v62, v[72:75], s[18:19] sc1
    s_waitcnt lgkmcnt(0)
    v_fmac_f32 v76, v46, v100
    v_fmac_f32 v77, v46, v101
    v_fmac_f32 v78, v46, v102
    v_fmac_f32 v79, v46, v103
    v_perm_b32 v76, v76, v66, s40
    v_perm_b32 v77, v77, v66, s41
    v_perm_b32 v78, v78, v66, s42
    v_perm_b32 v79, v79, v66, s43
    global_store_dwordx4 v63, v[76:79], s[18:19] sc1
    s_mov_b64 exec, s[48:49]
    global_store_dwordx4 v57, v[64:67], s[18:19] sc1
    s_waitcnt vmcnt(0)
    s_barrier
L_end:
    s_endpgm
L_sched:
    s_setprio 3
    s_mov_b32 s89, s83
    v_lshlrev_b32 v20, 4, v15
    v_add_u32 v21, 4096, v20
    v_add_u32 v22, 8192, v20
    v_add_u32 v23, 12288, v20
    s_waitcnt lgkmcnt(0)
    s_load_dwordx2 s[28:29], s[12:13], 0
    s_load_dword s20, s[10:11], s50 offset:512
    s_load_dword s21, s[10:11], s50 offset:8704
    s_load_dword s22, s[10:11], s50 offset:2560
    s_load_dword s23, s[10:11], s50 offset:10752
    global_load_dwordx4 v[104:107], v20, s[10:11] offset:0
    global_load_dwordx4 v[108:111], v20, s[10:11] offset:1024
    global_load_dwordx4 v[112:115], v20, s[10:11] offset:2048
    global_load_dwordx4 v[116:119], v20, s[10:11] offset:3072
    global_load_dwordx4 v[120:123], v21, s[10:11] offset:0
    global_load_dwordx4 v[124:127], v21, s[10:11] offset:1024
    global_load_dwordx4 v[128:131], v21, s[10:11] offset:2048
    global_load_dwordx4 v[132:135], v21, s[10:11] offset:3072
    global_load_dwordx4 v[136:139], v22, s[10:11] offset:0
    global_load_dwordx4 v[140:143], v22, s[10:11] offset:1024
    global_load_dwordx4 v[144:147], v22, s[10:11] offset:2048
    global_load_dwordx4 v[148:151], v22, s[10:11] offset:3072
    global_load_dwordx4 v[152:155], v23, s[10:11] offset:0
    global_load_dwordx4 v[156:159], v23, s[10:11] offset:1024
    global_load_dwordx4 v[160:163], v23, s[10:11] offset:2048
    global_load_dwordx4 v[164:167], v23, s[10:11] offset:3072
    s_lshr_b32 s42, s2, 5
    s_and_b32 s42, s42, 1
    s_lshl_b32 s68, s30, 11
    s_add_u32 s68, s68, 0x250000
    s_lshl_b32 s51, s30, 2
    v_mov_b32 v36, s51
    v_mov_b32 v38, 1
    v_mov_b32 v39, 2
    v_lshlrev_b32 v24, 2, v15
    v_add_u32 v6, 24832, v24
    v_add_u32 v7, 24880, v24
    s_mov_b32 s43, 0
    s_mov_b32 s69, 0
    s_mov_b32 s36, 0
    s_mov_b32 s33, 0
    s_mov_b32 s88, 0
    s_mov_b32 s49, 0
    s_waitcnt lgkmcnt(0)
    s_cmp_gt_i32 s28, 0
    s_cselect_b32 s56, -1, 0
    s_cselect_b32 s28, s28, 0x8000
    s_min_u32 s28, s28, 0x8000
    s_cmp_gt_i32 s29, 0
    s_cselect_b32 s57, -1, 0
    s_cselect_b32 s29, s29, 0x8000
    s_min_u32 s29, s29, 0x8000
    s_mov_b32 s57, 0
    s_add_u32 s34, s28, 15
    s_lshr_b32 s34, s34, 4
    s_add_u32 s35, s29, 15
    s_lshr_b32 s35, s35, 4
    s_cmp_ge_u32 s34, 1024
    s_cselect_b32 s41, 6, 0
    s_add_u32 s3, s41, 2
    s_cmp_eq_u32 s41, 0
    s_cbranch_scc1 L_nofast0
    s_add_u32 s50, s89, 128
    s_lshl_b32 s50, s50, 4
    s_sub_i32 s53, s28, s50
    s_sub_i32 s54, s29, s50
    s_max_i32 s53, s53, 0
    s_max_i32 s54, s54, 0
    s_min_i32 s53, s53, 16
    s_min_i32 s54, s54, 16
    s_cmp_eq_u32 s20, s21
    s_cselect_b32 s54, s54, 0
    s_lshl_b32 s54, s54, 8
    s_or_b32 s54, s54, s53
    s_pack_ll_b32_b16 s55, s54, s20
    s_or_b32 s55, s55, 0x20
    v_mov_b32 v25, s55
    s_add_u32 s50, s89, 640
    s_lshl_b32 s50, s50, 4
    s_sub_i32 s53, s28, s50
    s_sub_i32 s54, s29, s50
    s_max_i32 s53, s53, 0
    s_max_i32 s54, s54, 0
    s_min_i32 s53, s53, 16
    s_min_i32 s54, s54, 16
    s_cmp_eq_u32 s22, s23
    s_cselect_b32 s54, s54, 0
    s_lshl_b32 s54, s54, 8
    s_or_b32 s54, s54, s53
    s_pack_ll_b32_b16 s55, s54, s22
    v_writelane_b32 v25, s55, 1
    s_mov_b64 exec, 3
    ds_write_b32 v6, v25
    ds_write_b32 v7, v25
    s_mov_b64 exec, -1
    v_xor_b32 v6, 8, v6
    v_add_u32 v7, 8, v7
L_nofast0:
    s_lshl_b32 s50, s89, 2
    s_load_dword s24, s[10:11], s50 offset:768
    s_load_dword s25, s[10:11], s50 offset:8960
    s_load_dword s26, s[10:11], s50 offset:2816
    s_load_dword s27, s[10:11], s50 offset:11008
    s_load_dword s4, s[10:11], s50 offset:1024
    s_load_dword s5, s[10:11], s50 offset:9216
    s_load_dword s6, s[10:11], s50 offset:3072
    s_load_dword s7, s[10:11], s50 offset:11264
    s_load_dword s8, s[10:11], s50 offset:1280
    s_load_dword s9, s[10:11], s50 offset:9472
    s_load_dword s91, s[10:11], s50 offset:3328
    s_load_dword s92, s[10:11], s50 offset:11520
    s_load_dword s93, s[10:11], s50 offset:1536
    s_load_dword s94, s[10:11], s50 offset:9728
    s_load_dword s95, s[10:11], s50 offset:3584
    s_load_dword s96, s[10:11], s50 offset:11776
    s_load_dword s97, s[10:11], s50 offset:1792
    s_load_dword s98, s[10:11], s50 offset:9984
    s_load_dword s99, s[10:11], s50 offset:3840
    s_load_dword s100, s[10:11], s50 offset:12032
    s_waitcnt lgkmcnt(0)
    s_mul_i32 s51, s30, 2048
    s_add_u32 s51, s51, 0x242000
    v_lshl_add_u32 v62, v15, 8, s51
    s_and_b32 s52, s31, 7
    s_lshl_b32 s52, s52, 8
    s_add_u32 s51, s51, s52
    v_mov_b32 v63, s51
    s_cmp_lg_u32 s31, 0
    s_cbranch_scc1 L_noinit
    v_lshl_add_u32 v26, v15, 8, s68
    v_mov_b32 v27, 0
    s_mov_b64 exec, 0xf
    global_store_dword v26, v27, s[18:19] sc1
    s_bfm_b64 exec, 8, 0
    global_store_dword v62, v27, s[18:19] sc1
    s_memrealtime s[44:45]
    s_waitcnt lgkmcnt(0)
    s_mul_i32 s45, s45, 0x85ebca6b
    s_xor_b32 s44, s44, s45
    s_mul_i32 s44, s44, 0x9e3779b1
    s_lshr_b32 s45, s44, 15
    s_xor_b32 s44, s44, s45
    s_mul_i32 s44, s44, 0x846ca68b
    s_max_u32 s44, s44, 1
    v_mov_b32 v28, s44
    s_mov_b64 exec, 1
    s_waitcnt vmcnt(0)
    global_store_dword v36, v28, s[16:17] sc1
    s_mov_b64 exec, -1
L_noinit:
    s_cmp_eq_u32 s41, 0
    s_cbranch_scc1 L_nofast1
    s_add_u32 s50, s89, 192
    s_lshl_b32 s50, s50, 4
    s_sub_i32 s53, s28, s50
    s_sub_i32 s54, s29, s50
    s_max_i32 s53, s53, 0
    s_max_i32 s54, s54, 0
    s_min_i32 s53, s53, 16
    s_min_i32 s54, s54, 16
    s_cmp_eq_u32 s24, s25
    s_cselect_b32 s54, s54, 0
    s_lshl_b32 s54, s54, 8
    s_or_b32 s54, s54, s53
    s_pack_ll_b32_b16 s55, s54, s24
    s_or_b32 s55, s55, 0x20
    v_mov_b32 v25, s55
    s_add_u32 s50, s89, 704
    s_lshl_b32 s50, s50, 4
    s_sub_i32 s53, s28, s50
    s_sub_i32 s54, s29, s50
    s_max_i32 s53, s53, 0
    s_max_i32 s54, s54, 0
    s_min_i32 s53, s53, 16
    s_min_i32 s54, s54, 16
    s_cmp_eq_u32 s26, s27
    s_cselect_b32 s54, s54, 0
    s_lshl_b32 s54, s54, 8
    s_or_b32 s54, s54, s53
    s_pack_ll_b32_b16 s55, s54, s26
    v_writelane_b32 v25, s55, 1
    s_waitcnt lgkmcnt(0)
    s_barrier
    s_mov_b64 exec, 3
    ds_write_b32 v6, v25
    ds_write_b32 v7, v25
    s_mov_b64 exec, -1
    v_xor_b32 v6, 8, v6
    v_add_u32 v7, 8, v7
L_nofast1:
    s_waitcnt vmcnt(0)
    ds_write_b128 v20, v[104:107] offset:0
    ds_write_b128 v20, v[136:139] offset:8192
    v_add_u32 v28, 0, v24
    v_add_u32 v29, 1, v24
    v_add_u32 v30, 2, v24
    v_add_u32 v31, 3, v24
    v_cmp_eq_u32 s[78:79], v104, v136
    v_cmp_eq_u32 s[80:81], v105, v137
    v_cmp_eq_u32 s[82:83], v106, v138
    v_cmp_eq_u32 s[84:85], v107, v139
    v_cmp_gt_u32 s[44:45], s34, v28
    v_cmp_gt_u32 s[70:71], s35, v28
    s_and_b64 s[44:45], s[44:45], s[78:79]
    s_andn2_b64 s[70:71], s[70:71], s[44:45]
    v_cmp_gt_u32 s[44:45], s34, v29
    v_cmp_gt_u32 s[72:73], s35, v29
    s_and_b64 s[44:45], s[44:45], s[80:81]
    s_andn2_b64 s[72:73], s[72:73], s[44:45]
    v_cmp_gt_u32 s[44:45], s34, v30
    v_cmp_gt_u32 s[74:75], s35, v30
    s_and_b64 s[44:45], s[44:45], s[82:83]
    s_andn2_b64 s[74:75], s[74:75], s[44:45]
    v_cmp_gt_u32 s[44:45], s34, v31
    v_cmp_gt_u32 s[76:77], s35, v31
    s_and_b64 s[44:45], s[44:45], s[84:85]
    s_andn2_b64 s[76:77], s[76:77], s[44:45]
    s_or_b64 s[44:45], s[70:71], s[72:73]
    s_or_b64 s[46:47], s[74:75], s[76:77]
    s_or_b64 s[44:45], s[44:45], s[46:47]
    s_cbranch_scc0 L_nob0
    v_mov_b32 v26, s36
    v_mbcnt_lo_u32_b32 v26, s70, v26
    v_mbcnt_hi_u32_b32 v26, s71, v26
    s_bcnt1_i32_b64 s50, s[70:71]
    s_add_u32 s36, s36, s50
    v_mbcnt_lo_u32_b32 v26, s72, v26
    v_mbcnt_hi_u32_b32 v26, s73, v26
    s_bcnt1_i32_b64 s50, s[72:73]
    s_add_u32 s36, s36, s50
    v_mbcnt_lo_u32_b32 v26, s74, v26
    v_mbcnt_hi_u32_b32 v26, s75, v26
    s_bcnt1_i32_b64 s50, s[74:75]
    s_add_u32 s36, s36, s50
    v_mbcnt_lo_u32_b32 v26, s76, v26
    v_mbcnt_hi_u32_b32 v26, s77, v26
    s_bcnt1_i32_b64 s50, s[76:77]
    s_add_u32 s36, s36, s50
    v_lshlrev_b32 v27, 2, v26
    s_mov_b64 exec, s[70:71]
    ds_write_b32 v27, v28 offset:16384
    v_add_u32 v26, 1, v26
    s_mov_b64 exec, -1
    v_lshlrev_b32 v27, 2, v26
    s_mov_b64 exec, s[72:73]
    ds_write_b32 v27, v29 offset:16384
    v_add_u32 v26, 1, v26
    s_mov_b64 exec, -1
    v_lshlrev_b32 v27, 2, v26
    s_mov_b64 exec, s[74:75]
    ds_write_b32 v27, v30 offset:16384
    v_add_u32 v26, 1, v26
    s_mov_b64 exec, -1
    v_lshlrev_b32 v27, 2, v26
    s_mov_b64 exec, s[76:77]
    ds_write_b32 v27, v31 offset:16384
    s_mov_b64 exec, -1
L_nob0:
    ds_write_b128 v20, v[108:111] offset:1024
    ds_write_b128 v20, v[140:143] offset:9216
    v_add_u32 v28, 256, v24
    v_add_u32 v29, 257, v24
    v_add_u32 v30, 258, v24
    v_add_u32 v31, 259, v24
    v_cmp_eq_u32 s[78:79], v108, v140
    v_cmp_eq_u32 s[80:81], v109, v141
    v_cmp_eq_u32 s[82:83], v110, v142
    v_cmp_eq_u32 s[84:85], v111, v143
    v_cmp_gt_u32 s[44:45], s34, v28
    v_cmp_gt_u32 s[70:71], s35, v28
    s_and_b64 s[44:45], s[44:45], s[78:79]
    s_andn2_b64 s[70:71], s[70:71], s[44:45]
    v_cmp_gt_u32 s[44:45], s34, v29
    v_cmp_gt_u32 s[72:73], s35, v29
    s_and_b64 s[44:45], s[44:45], s[80:81]
    s_andn2_b64 s[72:73], s[72:73], s[44:45]
    v_cmp_gt_u32 s[44:45], s34, v30
    v_cmp_gt_u32 s[74:75], s35, v30
    s_and_b64 s[44:45], s[44:45], s[82:83]
    s_andn2_b64 s[74:75], s[74:75], s[44:45]
    v_cmp_gt_u32 s[44:45], s34, v31
    v_cmp_gt_u32 s[76:77], s35, v31
    s_and_b64 s[44:45], s[44:45], s[84:85]
    s_andn2_b64 s[76:77], s[76:77], s[44:45]
    s_or_b64 s[44:45], s[70:71], s[72:73]
    s_or_b64 s[46:47], s[74:75], s[76:77]
    s_or_b64 s[44:45], s[44:45], s[46:47]
    s_cbranch_scc0 L_nob1
    v_mov_b32 v26, s36
    v_mbcnt_lo_u32_b32 v26, s70, v26
    v_mbcnt_hi_u32_b32 v26, s71, v26
    s_bcnt1_i32_b64 s50, s[70:71]
    s_add_u32 s36, s36, s50
    v_mbcnt_lo_u32_b32 v26, s72, v26
    v_mbcnt_hi_u32_b32 v26, s73, v26
    s_bcnt1_i32_b64 s50, s[72:73]
    s_add_u32 s36, s36, s50
    v_mbcnt_lo_u32_b32 v26, s74, v26
    v_mbcnt_hi_u32_b32 v26, s75, v26
    s_bcnt1_i32_b64 s50, s[74:75]
    s_add_u32 s36, s36, s50
    v_mbcnt_lo_u32_b32 v26, s76, v26
    v_mbcnt_hi_u32_b32 v26, s77, v26
    s_bcnt1_i32_b64 s50, s[76:77]
    s_add_u32 s36, s36, s50
    v_lshlrev_b32 v27, 2, v26
    s_mov_b64 exec, s[70:71]
    ds_write_b32 v27, v28 offset:16384
    v_add_u32 v26, 1, v26
    s_mov_b64 exec, -1
    v_lshlrev_b32 v27, 2, v26
    s_mov_b64 exec, s[72:73]
    ds_write_b32 v27, v29 offset:16384
    v_add_u32 v26, 1, v26
    s_mov_b64 exec, -1
    v_lshlrev_b32 v27, 2, v26
    s_mov_b64 exec, s[74:75]
    ds_write_b32 v27, v30 offset:16384
    v_add_u32 v26, 1, v26
    s_mov_b64 exec, -1
    v_lshlrev_b32 v27, 2, v26
    s_mov_b64 exec, s[76:77]
    ds_write_b32 v27, v31 offset:16384
    s_mov_b64 exec, -1
L_nob1:
    s_cmp_eq_u32 s41, 0
    s_cbranch_scc1 L_nofast2
    s_add_u32 s50, s89, 256
    s_lshl_b32 s50, s50, 4
    s_sub_i32 s53, s28, s50
    s_sub_i32 s54, s29, s50
    s_max_i32 s53, s53, 0
    s_max_i32 s54, s54, 0
    s_min_i32 s53, s53, 16
    s_min_i32 s54, s54, 16
    s_cmp_eq_u32 s4, s5
    s_cselect_b32 s54, s54, 0
    s_lshl_b32 s54, s54, 8
    s_or_b32 s54, s54, s53
    s_pack_ll_b32_b16 s55, s54, s4
    s_or_b32 s55, s55, 0x20
    v_mov_b32 v25, s55
    s_add_u32 s50, s89, 768
    s_lshl_b32 s50, s50, 4
    s_sub_i32 s53, s28, s50
    s_sub_i32 s54, s29, s50
    s_max_i32 s53, s53, 0
    s_max_i32 s54, s54, 0
    s_min_i32 s53, s53, 16
    s_min_i32 s54, s54, 16
    s_cmp_eq_u32 s6, s7
    s_cselect_b32 s54, s54, 0
    s_lshl_b32 s54, s54, 8
    s_or_b32 s54, s54, s53
    s_pack_ll_b32_b16 s55, s54, s6
    v_writelane_b32 v25, s55, 1
    s_waitcnt lgkmcnt(0)
    s_barrier
    s_mov_b64 exec, 3
    ds_write_b32 v6, v25
    ds_write_b32 v7, v25
    s_mov_b64 exec, -1
    v_xor_b32 v6, 8, v6
    v_add_u32 v7, 8, v7
L_nofast2:
    ds_write_b128 v20, v[112:115] offset:2048
    ds_write_b128 v20, v[144:147] offset:10240
    v_add_u32 v28, 512, v24
    v_add_u32 v29, 513, v24
    v_add_u32 v30, 514, v24
    v_add_u32 v31, 515, v24
    v_cmp_eq_u32 s[78:79], v112, v144
    v_cmp_eq_u32 s[80:81], v113, v145
    v_cmp_eq_u32 s[82:83], v114, v146
    v_cmp_eq_u32 s[84:85], v115, v147
    v_cmp_gt_u32 s[44:45], s34, v28
    v_cmp_gt_u32 s[70:71], s35, v28
    s_and_b64 s[44:45], s[44:45], s[78:79]
    s_andn2_b64 s[70:71], s[70:71], s[44:45]
    v_cmp_gt_u32 s[44:45], s34, v29
    v_cmp_gt_u32 s[72:73], s35, v29
    s_and_b64 s[44:45], s[44:45], s[80:81]
    s_andn2_b64 s[72:73], s[72:73], s[44:45]
    v_cmp_gt_u32 s[44:45], s34, v30
    v_cmp_gt_u32 s[74:75], s35, v30
    s_and_b64 s[44:45], s[44:45], s[82:83]
    s_andn2_b64 s[74:75], s[74:75], s[44:45]
    v_cmp_gt_u32 s[44:45], s34, v31
    v_cmp_gt_u32 s[76:77], s35, v31
    s_and_b64 s[44:45], s[44:45], s[84:85]
    s_andn2_b64 s[76:77], s[76:77], s[44:45]
    s_or_b64 s[44:45], s[70:71], s[72:73]
    s_or_b64 s[46:47], s[74:75], s[76:77]
    s_or_b64 s[44:45], s[44:45], s[46:47]
    s_cbranch_scc0 L_nob2
    v_mov_b32 v26, s36
    v_mbcnt_lo_u32_b32 v26, s70, v26
    v_mbcnt_hi_u32_b32 v26, s71, v26
    s_bcnt1_i32_b64 s50, s[70:71]
    s_add_u32 s36, s36, s50
    v_mbcnt_lo_u32_b32 v26, s72, v26
    v_mbcnt_hi_u32_b32 v26, s73, v26
    s_bcnt1_i32_b64 s50, s[72:73]
    s_add_u32 s36, s36, s50
    v_mbcnt_lo_u32_b32 v26, s74, v26
    v_mbcnt_hi_u32_b32 v26, s75, v26
    s_bcnt1_i32_b64 s50, s[74:75]
    s_add_u32 s36, s36, s50
    v_mbcnt_lo_u32_b32 v26, s76, v26
    v_mbcnt_hi_u32_b32 v26, s77, v26
    s_bcnt1_i32_b64 s50, s[76:77]
    s_add_u32 s36, s36, s50
    v_lshlrev_b32 v27, 2, v26
    s_mov_b64 exec, s[70:71]
    ds_write_b32 v27, v28 offset:16384
    v_add_u32 v26, 1, v26
    s_mov_b64 exec, -1
    v_lshlrev_b32 v27, 2, v26
    s_mov_b64 exec, s[72:73]
    ds_write_b32 v27, v29 offset:16384
    v_add_u32 v26, 1, v26
    s_mov_b64 exec, -1
    v_lshlrev_b32 v27, 2, v26
    s_mov_b64 exec, s[74:75]
    ds_write_b32 v27, v30 offset:16384
    v_add_u32 v26, 1, v26
    s_mov_b64 exec, -1
    v_lshlrev_b32 v27, 2, v26
    s_mov_b64 exec, s[76:77]
    ds_write_b32 v27, v31 offset:16384
    s_mov_b64 exec, -1
L_nob2:
    ds_write_b128 v20, v[116:119] offset:3072
    ds_write_b128 v20, v[148:151] offset:11264
    v_add_u32 v28, 768, v24
    v_add_u32 v29, 769, v24
    v_add_u32 v30, 770, v24
    v_add_u32 v31, 771, v24
    v_cmp_eq_u32 s[78:79], v116, v148
    v_cmp_eq_u32 s[80:81], v117, v149
    v_cmp_eq_u32 s[82:83], v118, v150
    v_cmp_eq_u32 s[84:85], v119, v151
    v_cmp_gt_u32 s[44:45], s34, v28
    v_cmp_gt_u32 s[70:71], s35, v28
    s_and_b64 s[44:45], s[44:45], s[78:79]
    s_andn2_b64 s[70:71], s[70:71], s[44:45]
    v_cmp_gt_u32 s[44:45], s34, v29
    v_cmp_gt_u32 s[72:73], s35, v29
    s_and_b64 s[44:45], s[44:45], s[80:81]
    s_andn2_b64 s[72:73], s[72:73], s[44:45]
    v_cmp_gt_u32 s[44:45], s34, v30
    v_cmp_gt_u32 s[74:75], s35, v30
    s_and_b64 s[44:45], s[44:45], s[82:83]
    s_andn2_b64 s[74:75], s[74:75], s[44:45]
    v_cmp_gt_u32 s[44:45], s34, v31
    v_cmp_gt_u32 s[76:77], s35, v31
    s_and_b64 s[44:45], s[44:45], s[84:85]
    s_andn2_b64 s[76:77], s[76:77], s[44:45]
    s_or_b64 s[44:45], s[70:71], s[72:73]
    s_or_b64 s[46:47], s[74:75], s[76:77]
    s_or_b64 s[44:45], s[44:45], s[46:47]
    s_cbranch_scc0 L_nob3
    v_mov_b32 v26, s36
    v_mbcnt_lo_u32_b32 v26, s70, v26
    v_mbcnt_hi_u32_b32 v26, s71, v26
    s_bcnt1_i32_b64 s50, s[70:71]
    s_add_u32 s36, s36, s50
    v_mbcnt_lo_u32_b32 v26, s72, v26
    v_mbcnt_hi_u32_b32 v26, s73, v26
    s_bcnt1_i32_b64 s50, s[72:73]
    s_add_u32 s36, s36, s50
    v_mbcnt_lo_u32_b32 v26, s74, v26
    v_mbcnt_hi_u32_b32 v26, s75, v26
    s_bcnt1_i32_b64 s50, s[74:75]
    s_add_u32 s36, s36, s50
    v_mbcnt_lo_u32_b32 v26, s76, v26
    v_mbcnt_hi_u32_b32 v26, s77, v26
    s_bcnt1_i32_b64 s50, s[76:77]
    s_add_u32 s36, s36, s50
    v_lshlrev_b32 v27, 2, v26
    s_mov_b64 exec, s[70:71]
    ds_write_b32 v27, v28 offset:16384
    v_add_u32 v26, 1, v26
    s_mov_b64 exec, -1
    v_lshlrev_b32 v27, 2, v26
    s_mov_b64 exec, s[72:73]
    ds_write_b32 v27, v29 offset:16384
    v_add_u32 v26, 1, v26
    s_mov_b64 exec, -1
    v_lshlrev_b32 v27, 2, v26
    s_mov_b64 exec, s[74:75]
    ds_write_b32 v27, v30 offset:16384
    v_add_u32 v26, 1, v26
    s_mov_b64 exec, -1
    v_lshlrev_b32 v27, 2, v26
    s_mov_b64 exec, s[76:77]
    ds_write_b32 v27, v31 offset:16384
    s_mov_b64 exec, -1
L_nob3:
    s_cmp_eq_u32 s41, 0
    s_cbranch_scc1 L_nofast3
    s_add_u32 s50, s89, 320
    s_lshl_b32 s50, s50, 4
    s_sub_i32 s53, s28, s50
    s_sub_i32 s54, s29, s50
    s_max_i32 s53, s53, 0
    s_max_i32 s54, s54, 0
    s_min_i32 s53, s53, 16
    s_min_i32 s54, s54, 16
    s_cmp_eq_u32 s8, s9
    s_cselect_b32 s54, s54, 0
    s_lshl_b32 s54, s54, 8
    s_or_b32 s54, s54, s53
    s_pack_ll_b32_b16 s55, s54, s8
    s_or_b32 s55, s55, 0x20
    v_mov_b32 v25, s55
    s_add_u32 s50, s89, 832
    s_lshl_b32 s50, s50, 4
    s_sub_i32 s53, s28, s50
    s_sub_i32 s54, s29, s50
    s_max_i32 s53, s53, 0
    s_max_i32 s54, s54, 0
    s_min_i32 s53, s53, 16
    s_min_i32 s54, s54, 16
    s_cmp_eq_u32 s91, s92
    s_cselect_b32 s54, s54, 0
    s_lshl_b32 s54, s54, 8
    s_or_b32 s54, s54, s53
    s_pack_ll_b32_b16 s55, s54, s91
    v_writelane_b32 v25, s55, 1
    s_waitcnt lgkmcnt(0)
    s_barrier
    s_mov_b64 exec, 3
    ds_write_b32 v6, v25
    ds_write_b32 v7, v25
    s_mov_b64 exec, -1
    v_xor_b32 v6, 8, v6
    v_add_u32 v7, 8, v7
L_nofast3:
    ds_write_b128 v20, v[120:123] offset:4096
    ds_write_b128 v20, v[152:155] offset:12288
    v_add_u32 v28, 1024, v24
    v_add_u32 v29, 1025, v24
    v_add_u32 v30, 1026, v24
    v_add_u32 v31, 1027, v24
    v_cmp_eq_u32 s[78:79], v120, v152
    v_cmp_eq_u32 s[80:81], v121, v153
    v_cmp_eq_u32 s[82:83], v122, v154
    v_cmp_eq_u32 s[84:85], v123, v155
    v_cmp_gt_u32 s[44:45], s34, v28
    v_cmp_gt_u32 s[70:71], s35, v28
    s_and_b64 s[44:45], s[44:45], s[78:79]
    s_andn2_b64 s[70:71], s[70:71], s[44:45]
    v_cmp_gt_u32 s[44:45], s34, v29
    v_cmp_gt_u32 s[72:73], s35, v29
    s_and_b64 s[44:45], s[44:45], s[80:81]
    s_andn2_b64 s[72:73], s[72:73], s[44:45]
    v_cmp_gt_u32 s[44:45], s34, v30
    v_cmp_gt_u32 s[74:75], s35, v30
    s_and_b64 s[44:45], s[44:45], s[82:83]
    s_andn2_b64 s[74:75], s[74:75], s[44:45]
    v_cmp_gt_u32 s[44:45], s34, v31
    v_cmp_gt_u32 s[76:77], s35, v31
    s_and_b64 s[44:45], s[44:45], s[84:85]
    s_andn2_b64 s[76:77], s[76:77], s[44:45]
    s_or_b64 s[44:45], s[70:71], s[72:73]
    s_or_b64 s[46:47], s[74:75], s[76:77]
    s_or_b64 s[44:45], s[44:45], s[46:47]
    s_cbranch_scc0 L_nob4
    v_mov_b32 v26, s36
    v_mbcnt_lo_u32_b32 v26, s70, v26
    v_mbcnt_hi_u32_b32 v26, s71, v26
    s_bcnt1_i32_b64 s50, s[70:71]
    s_add_u32 s36, s36, s50
    v_mbcnt_lo_u32_b32 v26, s72, v26
    v_mbcnt_hi_u32_b32 v26, s73, v26
    s_bcnt1_i32_b64 s50, s[72:73]
    s_add_u32 s36, s36, s50
    v_mbcnt_lo_u32_b32 v26, s74, v26
    v_mbcnt_hi_u32_b32 v26, s75, v26
    s_bcnt1_i32_b64 s50, s[74:75]
    s_add_u32 s36, s36, s50
    v_mbcnt_lo_u32_b32 v26, s76, v26
    v_mbcnt_hi_u32_b32 v26, s77, v26
    s_bcnt1_i32_b64 s50, s[76:77]
    s_add_u32 s36, s36, s50
    v_lshlrev_b32 v27, 2, v26
    s_mov_b64 exec, s[70:71]
    ds_write_b32 v27, v28 offset:16384
    v_add_u32 v26, 1, v26
    s_mov_b64 exec, -1
    v_lshlrev_b32 v27, 2, v26
    s_mov_b64 exec, s[72:73]
    ds_write_b32 v27, v29 offset:16384
    v_add_u32 v26, 1, v26
    s_mov_b64 exec, -1
    v_lshlrev_b32 v27, 2, v26
    s_mov_b64 exec, s[74:75]
    ds_write_b32 v27, v30 offset:16384
    v_add_u32 v26, 1, v26
    s_mov_b64 exec, -1
    v_lshlrev_b32 v27, 2, v26
    s_mov_b64 exec, s[76:77]
    ds_write_b32 v27, v31 offset:16384
    s_mov_b64 exec, -1
L_nob4:
    ds_write_b128 v20, v[124:127] offset:5120
    ds_write_b128 v20, v[156:159] offset:13312
    v_add_u32 v28, 1280, v24
    v_add_u32 v29, 1281, v24
    v_add_u32 v30, 1282, v24
    v_add_u32 v31, 1283, v24
    v_cmp_eq_u32 s[78:79], v124, v156
    v_cmp_eq_u32 s[80:81], v125, v157
    v_cmp_eq_u32 s[82:83], v126, v158
    v_cmp_eq_u32 s[84:85], v127, v159
    v_cmp_gt_u32 s[44:45], s34, v28
    v_cmp_gt_u32 s[70:71], s35, v28
    s_and_b64 s[44:45], s[44:45], s[78:79]
    s_andn2_b64 s[70:71], s[70:71], s[44:45]
    v_cmp_gt_u32 s[44:45], s34, v29
    v_cmp_gt_u32 s[72:73], s35, v29
    s_and_b64 s[44:45], s[44:45], s[80:81]
    s_andn2_b64 s[72:73], s[72:73], s[44:45]
    v_cmp_gt_u32 s[44:45], s34, v30
    v_cmp_gt_u32 s[74:75], s35, v30
    s_and_b64 s[44:45], s[44:45], s[82:83]
    s_andn2_b64 s[74:75], s[74:75], s[44:45]
    v_cmp_gt_u32 s[44:45], s34, v31
    v_cmp_gt_u32 s[76:77], s35, v31
    s_and_b64 s[44:45], s[44:45], s[84:85]
    s_andn2_b64 s[76:77], s[76:77], s[44:45]
    s_or_b64 s[44:45], s[70:71], s[72:73]
    s_or_b64 s[46:47], s[74:75], s[76:77]
    s_or_b64 s[44:45], s[44:45], s[46:47]
    s_cbranch_scc0 L_nob5
    v_mov_b32 v26, s36
    v_mbcnt_lo_u32_b32 v26, s70, v26
    v_mbcnt_hi_u32_b32 v26, s71, v26
    s_bcnt1_i32_b64 s50, s[70:71]
    s_add_u32 s36, s36, s50
    v_mbcnt_lo_u32_b32 v26, s72, v26
    v_mbcnt_hi_u32_b32 v26, s73, v26
    s_bcnt1_i32_b64 s50, s[72:73]
    s_add_u32 s36, s36, s50
    v_mbcnt_lo_u32_b32 v26, s74, v26
    v_mbcnt_hi_u32_b32 v26, s75, v26
    s_bcnt1_i32_b64 s50, s[74:75]
    s_add_u32 s36, s36, s50
    v_mbcnt_lo_u32_b32 v26, s76, v26
    v_mbcnt_hi_u32_b32 v26, s77, v26
    s_bcnt1_i32_b64 s50, s[76:77]
    s_add_u32 s36, s36, s50
    v_lshlrev_b32 v27, 2, v26
    s_mov_b64 exec, s[70:71]
    ds_write_b32 v27, v28 offset:16384
    v_add_u32 v26, 1, v26
    s_mov_b64 exec, -1
    v_lshlrev_b32 v27, 2, v26
    s_mov_b64 exec, s[72:73]
    ds_write_b32 v27, v29 offset:16384
    v_add_u32 v26, 1, v26
    s_mov_b64 exec, -1
    v_lshlrev_b32 v27, 2, v26
    s_mov_b64 exec, s[74:75]
    ds_write_b32 v27, v30 offset:16384
    v_add_u32 v26, 1, v26
    s_mov_b64 exec, -1
    v_lshlrev_b32 v27, 2, v26
    s_mov_b64 exec, s[76:77]
    ds_write_b32 v27, v31 offset:16384
    s_mov_b64 exec, -1
L_nob5:
    s_cmp_eq_u32 s41, 0
    s_cbranch_scc1 L_nofast4
    s_add_u32 s50, s89, 384
    s_lshl_b32 s50, s50, 4
    s_sub_i32 s53, s28, s50
    s_sub_i32 s54, s29, s50
    s_max_i32 s53, s53, 0
    s_max_i32 s54, s54, 0
    s_min_i32 s53, s53, 16
    s_min_i32 s54, s54, 16
    s_cmp_eq_u32 s93, s94
    s_cselect_b32 s54, s54, 0
    s_lshl_b32 s54, s54, 8
    s_or_b32 s54, s54, s53
    s_pack_ll_b32_b16 s55, s54, s93
    s_or_b32 s55, s55, 0x20
    v_mov_b32 v25, s55
    s_add_u32 s50, s89, 896
    s_lshl_b32 s50, s50, 4
    s_sub_i32 s53, s28, s50
    s_sub_i32 s54, s29, s50
    s_max_i32 s53, s53, 0
    s_max_i32 s54, s54, 0
    s_min_i32 s53, s53, 16
    s_min_i32 s54, s54, 16
    s_cmp_eq_u32 s95, s96
    s_cselect_b32 s54, s54, 0
    s_lshl_b32 s54, s54, 8
    s_or_b32 s54, s54, s53
    s_pack_ll_b32_b16 s55, s54, s95
    v_writelane_b32 v25, s55, 1
    s_waitcnt lgkmcnt(0)
    s_barrier
    s_mov_b64 exec, 3
    ds_write_b32 v6, v25
    ds_write_b32 v7, v25
    s_mov_b64 exec, -1
    v_xor_b32 v6, 8, v6
    v_add_u32 v7, 8, v7
L_nofast4:
    ds_write_b128 v20, v[128:131] offset:6144
    ds_write_b128 v20, v[160:163] offset:14336
    v_add_u32 v28, 1536, v24
    v_add_u32 v29, 1537, v24
    v_add_u32 v30, 1538, v24
    v_add_u32 v31, 1539, v24
    v_cmp_eq_u32 s[78:79], v128, v160
    v_cmp_eq_u32 s[80:81], v129, v161
    v_cmp_eq_u32 s[82:83], v130, v162
    v_cmp_eq_u32 s[84:85], v131, v163
    v_cmp_gt_u32 s[44:45], s34, v28
    v_cmp_gt_u32 s[70:71], s35, v28
    s_and_b64 s[44:45], s[44:45], s[78:79]
    s_andn2_b64 s[70:71], s[70:71], s[44:45]
    v_cmp_gt_u32 s[44:45], s34, v29
    v_cmp_gt_u32 s[72:73], s35, v29
    s_and_b64 s[44:45], s[44:45], s[80:81]
    s_andn2_b64 s[72:73], s[72:73], s[44:45]
    v_cmp_gt_u32 s[44:45], s34, v30
    v_cmp_gt_u32 s[74:75], s35, v30
    s_and_b64 s[44:45], s[44:45], s[82:83]
    s_andn2_b64 s[74:75], s[74:75], s[44:45]
    v_cmp_gt_u32 s[44:45], s34, v31
    v_cmp_gt_u32 s[76:77], s35, v31
    s_and_b64 s[44:45], s[44:45], s[84:85]
    s_andn2_b64 s[76:77], s[76:77], s[44:45]
    s_or_b64 s[44:45], s[70:71], s[72:73]
    s_or_b64 s[46:47], s[74:75], s[76:77]
    s_or_b64 s[44:45], s[44:45], s[46:47]
    s_cbranch_scc0 L_nob6
    v_mov_b32 v26, s36
    v_mbcnt_lo_u32_b32 v26, s70, v26
    v_mbcnt_hi_u32_b32 v26, s71, v26
    s_bcnt1_i32_b64 s50, s[70:71]
    s_add_u32 s36, s36, s50
    v_mbcnt_lo_u32_b32 v26, s72, v26
    v_mbcnt_hi_u32_b32 v26, s73, v26
    s_bcnt1_i32_b64 s50, s[72:73]
    s_add_u32 s36, s36, s50
    v_mbcnt_lo_u32_b32 v26, s74, v26
    v_mbcnt_hi_u32_b32 v26, s75, v26
    s_bcnt1_i32_b64 s50, s[74:75]
    s_add_u32 s36, s36, s50
    v_mbcnt_lo_u32_b32 v26, s76, v26
    v_mbcnt_hi_u32_b32 v26, s77, v26
    s_bcnt1_i32_b64 s50, s[76:77]
    s_add_u32 s36, s36, s50
    v_lshlrev_b32 v27, 2, v26
    s_mov_b64 exec, s[70:71]
    ds_write_b32 v27, v28 offset:16384
    v_add_u32 v26, 1, v26
    s_mov_b64 exec, -1
    v_lshlrev_b32 v27, 2, v26
    s_mov_b64 exec, s[72:73]
    ds_write_b32 v27, v29 offset:16384
    v_add_u32 v26, 1, v26
    s_mov_b64 exec, -1
    v_lshlrev_b32 v27, 2, v26
    s_mov_b64 exec, s[74:75]
    ds_write_b32 v27, v30 offset:16384
    v_add_u32 v26, 1, v26
    s_mov_b64 exec, -1
    v_lshlrev_b32 v27, 2, v26
    s_mov_b64 exec, s[76:77]
    ds_write_b32 v27, v31 offset:16384
    s_mov_b64 exec, -1
L_nob6:
    ds_write_b128 v20, v[132:135] offset:7168
    ds_write_b128 v20, v[164:167] offset:15360
    v_add_u32 v28, 1792, v24
    v_add_u32 v29, 1793, v24
    v_add_u32 v30, 1794, v24
    v_add_u32 v31, 1795, v24
    v_cmp_eq_u32 s[78:79], v132, v164
    v_cmp_eq_u32 s[80:81], v133, v165
    v_cmp_eq_u32 s[82:83], v134, v166
    v_cmp_eq_u32 s[84:85], v135, v167
    v_cmp_gt_u32 s[44:45], s34, v28
    v_cmp_gt_u32 s[70:71], s35, v28
    s_and_b64 s[44:45], s[44:45], s[78:79]
    s_andn2_b64 s[70:71], s[70:71], s[44:45]
    v_cmp_gt_u32 s[44:45], s34, v29
    v_cmp_gt_u32 s[72:73], s35, v29
    s_and_b64 s[44:45], s[44:45], s[80:81]
    s_andn2_b64 s[72:73], s[72:73], s[44:45]
    v_cmp_gt_u32 s[44:45], s34, v30
    v_cmp_gt_u32 s[74:75], s35, v30
    s_and_b64 s[44:45], s[44:45], s[82:83]
    s_andn2_b64 s[74:75], s[74:75], s[44:45]
    v_cmp_gt_u32 s[44:45], s34, v31
    v_cmp_gt_u32 s[76:77], s35, v31
    s_and_b64 s[44:45], s[44:45], s[84:85]
    s_andn2_b64 s[76:77], s[76:77], s[44:45]
    s_or_b64 s[44:45], s[70:71], s[72:73]
    s_or_b64 s[46:47], s[74:75], s[76:77]
    s_or_b64 s[44:45], s[44:45], s[46:47]
    s_cbranch_scc0 L_nob7
    v_mov_b32 v26, s36
    v_mbcnt_lo_u32_b32 v26, s70, v26
    v_mbcnt_hi_u32_b32 v26, s71, v26
    s_bcnt1_i32_b64 s50, s[70:71]
    s_add_u32 s36, s36, s50
    v_mbcnt_lo_u32_b32 v26, s72, v26
    v_mbcnt_hi_u32_b32 v26, s73, v26
    s_bcnt1_i32_b64 s50, s[72:73]
    s_add_u32 s36, s36, s50
    v_mbcnt_lo_u32_b32 v26, s74, v26
    v_mbcnt_hi_u32_b32 v26, s75, v26
    s_bcnt1_i32_b64 s50, s[74:75]
    s_add_u32 s36, s36, s50
    v_mbcnt_lo_u32_b32 v26, s76, v26
    v_mbcnt_hi_u32_b32 v26, s77, v26
    s_bcnt1_i32_b64 s50, s[76:77]
    s_add_u32 s36, s36, s50
    v_lshlrev_b32 v27, 2, v26
    s_mov_b64 exec, s[70:71]
    ds_write_b32 v27, v28 offset:16384
    v_add_u32 v26, 1, v26
    s_mov_b64 exec, -1
    v_lshlrev_b32 v27, 2, v26
    s_mov_b64 exec, s[72:73]
    ds_write_b32 v27, v29 offset:16384
    v_add_u32 v26, 1, v26
    s_mov_b64 exec, -1
    v_lshlrev_b32 v27, 2, v26
    s_mov_b64 exec, s[74:75]
    ds_write_b32 v27, v30 offset:16384
    v_add_u32 v26, 1, v26
    s_mov_b64 exec, -1
    v_lshlrev_b32 v27, 2, v26
    s_mov_b64 exec, s[76:77]
    ds_write_b32 v27, v31 offset:16384
    s_mov_b64 exec, -1
L_nob7:
    s_add_u32 s37, s34, s36
    s_min_u32 s38, s34, 256
    s_lshl_b32 s50, s41, 7
    s_add_u32 s38, s38, s50
    s_mul_i32 s87, s37, 216
    s_lshr_b32 s87, s87, 8
    s_mul_i32 s40, s87, 206
    s_lshr_b32 s40, s40, 15
    s_max_u32 s40, s40, 10
    s_min_u32 s40, s40, 23
    s_sub_u32 s40, s40, 2
    s_sub_u32 s35, s40, s41
    s_lshl_b32 s35, s35, 6
    s_lshl1_add_u32 s39, s35, s38
    s_max_u32 s87, s87, s39
    s_min_u32 s86, s87, s37
    s_max_u32 s86, s86, s39
    s_sub_u32 s86, s86, s39
    s_lshr_b32 s50, s31, 6
    s_mul_i32 s50, s50, s35
    s_lshr_b32 s50, s50, 0
    s_add_u32 s38, s38, s50
    s_and_b32 s50, s31, 63
    s_add_u32 s38, s38, s50
    s_cmp_eq_u32 s41, 0
    s_cbranch_scc1 L_nofast5
    s_add_u32 s50, s89, 448
    s_lshl_b32 s50, s50, 4
    s_sub_i32 s53, s28, s50
    s_sub_i32 s54, s29, s50
    s_max_i32 s53, s53, 0
    s_max_i32 s54, s54, 0
    s_min_i32 s53, s53, 16
    s_min_i32 s54, s54, 16
    s_cmp_eq_u32 s97, s98
    s_cselect_b32 s54, s54, 0
    s_lshl_b32 s54, s54, 8
    s_or_b32 s54, s54, s53
    s_pack_ll_b32_b16 s55, s54, s97
    s_or_b32 s55, s55, 0x20
    v_mov_b32 v25, s55
    s_add_u32 s50, s89, 960
    s_lshl_b32 s50, s50, 4
    s_sub_i32 s53, s28, s50
    s_sub_i32 s54, s29, s50
    s_max_i32 s53, s53, 0
    s_max_i32 s54, s54, 0
    s_min_i32 s53, s53, 16
    s_min_i32 s54, s54, 16
    s_cmp_eq_u32 s99, s100
    s_cselect_b32 s54, s54, 0
    s_lshl_b32 s54, s54, 8
    s_or_b32 s54, s54, s53
    s_pack_ll_b32_b16 s55, s54, s99
    v_writelane_b32 v25, s55, 1
    s_waitcnt lgkmcnt(0)
    s_barrier
    s_mov_b64 exec, 3
    ds_write_b32 v6, v25
    ds_write_b32 v7, v25
    s_mov_b64 exec, -1
    v_xor_b32 v6, 8, v6
    v_add_u32 v7, 8, v7
L_nofast5:
    s_lshl_b32 s51, s30, 6
    s_add_u32 s51, s51, s31
    s_lshl_b32 s52, s51, 13
    v_lshl_add_u32 v57, v15, 4, s52
    v_add_u32 v58, 4096, v57
    s_lshl_b32 s52, s51, 10
    s_add_u32 s52, s52, 0x200000
    v_lshrrev_b32 v59, 3, v15
    v_lshl_add_u32 v59, v59, 4, s52
    s_bfe_u32 s52, s51, 0x10004
    s_lshl_b32 s52, s52, 13
    s_lshr_b32 s53, s51, 5
    s_lshl_b32 s53, s53, 10
    s_add_u32 s52, s52, s53
    s_and_b32 s53, s51, 15
    s_lshl_b32 s53, s53, 6
    s_add_u32 s52, s52, s53
    v_and_b32 v60, 3, v15
    v_lshl_add_u32 v60, v60, 4, s52
    v_and_b32 v61, 4, v15
    v_lshl_add_u32 v60, v61, 1, v60
    s_lshl_b32 s51, s30, 14
    s_lshr_b32 s52, s31, 3
    s_lshl_b32 s52, s52, 5
    s_add_u32 s51, s51, s52
    s_add_u32 s51, s51, 0x200000
    v_lshrrev_b32 v64, 3, v15
    v_lshl_add_u32 v64, v64, 8, s51
    v_add_u32 v65, 0x1000, v64
    v_add_u32 v66, 0x2000, v64
    v_add_u32 v67, 0x3000, v64
    s_cmp_eq_u32 s41, 0
    s_cbranch_scc1 L_nofast6
    s_waitcnt lgkmcnt(0)
    s_barrier
L_nofast6:
    s_mov_b32 s91, -1
    s_mov_b32 s92, -1
    s_mov_b32 s93, -1
    s_mov_b32 s94, -1
L_sloop:
    s_cmp_eq_u32 s33, 2
    s_cbranch_scc1 L_sv
    s_cmp_eq_u32 s33, 3
    s_cbranch_scc1 L_skv
    s_cmp_eq_u32 s33, 1
    s_cbranch_scc1 L_sdk
    s_cmp_eq_u32 s33, 4
    s_cbranch_scc1 L_fterm
    s_cmp_lt_u32 s38, s37
    s_cbranch_scc1 L_sfix
    s_mov_b32 s69, 15
    s_mov_b32 s33, 2
    s_branch L_putempty
L_sfix:
    s_mov_b32 s89, s38
    s_add_u32 s90, s38, s35
    s_add_u32 s38, s38, 64
    s_add_u32 s41, s41, 1
    s_add_u32 s50, s41, 1
    s_cmp_lg_u32 s50, s40
    s_cbranch_scc1 L_nopre
    global_load_dword v32, v36, s[16:17] sc1
L_nopre:
    s_cmp_lg_u32 s41, s40
    s_cbranch_scc1 L_putkk
    s_waitcnt vmcnt(0)
    v_readfirstlane_b32 s52, v32
    s_mov_b32 s43, 1
    s_cmp_lg_u32 s52, 0
    s_cbranch_scc1 L_ready
    s_mov_b32 s51, 0
L_polli:
    global_load_dword v32, v36, s[16:17] sc1
    s_add_u32 s51, s51, 1
    s_waitcnt vmcnt(0)
    v_readfirstlane_b32 s52, v32
    s_cmp_ge_u32 s51, 0x80000
    s_cbranch_scc1 L_polledi
    s_cmp_eq_u32 s52, 0
    s_cbranch_scc1 L_polli
L_polledi:
    s_mov_b32 s43, 1
L_ready:
    s_mov_b32 s33, 1
    s_and_b32 s50, s69, 3
    s_cmp_eq_u32 s50, 3
    s_cselect_b32 s48, 2, 0
    s_xor_b32 s42, s42, 1
    s_or_b32 s48, s48, s42
    s_bitcmp1_b32 s69, s48
    s_cselect_b32 s50, 1, 0
    s_xor_b32 s48, s48, s50
    s_lshl_b32 s50, s48, 8
    s_add_u32 s50, s50, s68
    v_mov_b32 v37, s50
    s_lshl_b64 exec, 1, s49
    global_atomic_add v40, v37, v39, s[18:19] sc0
    s_mov_b64 exec, -1
    s_xor_b32 s49, s49, 1
    s_mov_b32 s67, s48
    s_branch L_putkk
L_sdk:
    s_add_u32 s50, s3, 2
    s_cmp_le_u32 s50, 24
    s_cbranch_scc1 L_sdk0
    s_mov_b32 s33, 2
    s_xor_b32 s52, s49, 1
    s_waitcnt vmcnt(0)
    s_branch L_sdk2
L_sdk0:
    s_and_b32 s50, s69, 3
    s_cmp_eq_u32 s50, 3
    s_cselect_b32 s48, 2, 0
    s_xor_b32 s42, s42, 1
    s_or_b32 s48, s48, s42
    s_bitcmp1_b32 s69, s48
    s_cselect_b32 s50, 1, 0
    s_xor_b32 s48, s48, s50
    s_lshl_b32 s50, s48, 8
    s_add_u32 s50, s50, s68
    v_mov_b32 v37, s50
    s_lshl_b64 exec, 1, s49
    global_atomic_add v40, v37, v39, s[18:19] sc0
    s_mov_b64 exec, -1
    s_xor_b32 s49, s49, 1
    s_mov_b32 s52, s49
    s_waitcnt vmcnt(1)
L_sdk2:
    v_readlane_b32 s51, v40, s52
    s_mov_b32 s50, s67
    s_mov_b32 s67, s48
    s_add_u32 s52, s51, 1
    s_and_b32 s54, s52, -2
    s_add_u32 s54, s54, s50
    s_and_b32 s53, s52, 1
    s_lshl1_add_u32 s55, s54, s53
    s_add_u32 s53, s55, s39
    s_cmp_lt_u32 s55, s86
    s_cselect_b32 s90, s53, -1
    s_and_b32 s54, s51, -2
    s_add_u32 s54, s54, s50
    s_and_b32 s53, s51, 1
    s_lshl1_add_u32 s55, s54, s53
    s_add_u32 s53, s55, s39
    s_cmp_lt_u32 s55, s86
    s_cselect_b32 s89, s53, -1
    s_cbranch_scc1 L_putkk
    s_bitset1_b32 s69, s50
    s_cmp_eq_u32 s33, 1
    s_cselect_b32 s57, 2, 0
    s_mov_b32 s33, 2
    s_branch L_sv
L_putkk:
    s_add_u32 s3, s3, 1
    s_mov_b32 s55, 0x20
    s_branch L_lookup
L_sv:
    s_lshl_b32 s50, s88, 3
    s_add_u32 s50, s50, 24864
    v_add_u32 v25, s50, v24
    ds_read_b32 v25, v25
    s_cmp_eq_u32 s88, 0
    s_cbranch_scc1 L_sv0
    s_cmp_eq_u32 s57, 0
    s_cbranch_scc1 L_sv0
    s_xor_b32 s52, s49, 1
    s_waitcnt vmcnt(0)
    v_readlane_b32 s51, v40, s52
    s_mov_b32 s50, s67
    s_mov_b32 s67, s48
    s_cmp_lg_u32 s57, 2
    s_cbranch_scc1 L_no2v
    s_add_u32 s52, s51, 1
    s_and_b32 s54, s52, -2
    s_add_u32 s54, s54, s50
    s_and_b32 s53, s52, 1
    s_lshl1_add_u32 s55, s54, s53
    s_add_u32 s53, s55, s39
    s_cmp_lt_u32 s55, s86
    s_cselect_b32 s90, s53, -1
    s_cmp_lg_u32 s90, -1
    s_cbranch_scc0 L_no2v
    s_mov_b32 s94, s93
    s_mov_b32 s93, s92
    s_mov_b32 s92, s91
    s_mov_b32 s91, s90
L_no2v:
    s_mov_b32 s57, 0
    s_and_b32 s54, s51, -2
    s_add_u32 s54, s54, s50
    s_and_b32 s53, s51, 1
    s_lshl1_add_u32 s55, s54, s53
    s_add_u32 s53, s55, s39
    s_cmp_lt_u32 s55, s86
    s_cselect_b32 s89, s53, -1
    s_cbranch_scc1 L_svh
    s_bitset1_b32 s69, s50
    s_branch L_sv0
L_svh:
    s_cmp_eq_u32 s89, -1
    s_cbranch_scc1 L_svi
    s_mov_b32 s94, s93
    s_mov_b32 s93, s92
    s_mov_b32 s92, s91
    s_mov_b32 s91, s89
L_svi:
    s_cmp_lg_u32 s93, -1
    s_cbranch_scc1 L_sv0
    s_and_b32 s50, s69, 3
    s_cmp_eq_u32 s50, 3
    s_cselect_b32 s48, 2, 0
    s_xor_b32 s42, s42, 1
    s_or_b32 s48, s48, s42
    s_bitcmp1_b32 s69, s48
    s_cselect_b32 s50, 1, 0
    s_xor_b32 s48, s48, s50
    s_lshl_b32 s50, s48, 8
    s_add_u32 s50, s50, s68
    v_mov_b32 v37, s50
    s_lshl_b64 exec, 1, s49
    global_atomic_add v40, v37, v38, s[18:19] sc0
    s_mov_b64 exec, -1
    s_xor_b32 s49, s49, 1
    s_mov_b32 s67, s48
    s_mov_b32 s57, 1
L_sv0:
    s_add_u32 s88, s88, 1
    s_cmp_lt_u32 s88, s3
    s_cbranch_scc1 L_sv1
    s_mov_b32 s33, 4
    s_cmp_eq_u32 s69, 15
    s_cbranch_scc1 L_sv1
    s_mov_b32 s33, 3
    s_cmp_lg_u32 s57, 0
    s_cbranch_scc1 L_sv1
    s_and_b32 s50, s69, 3
    s_cmp_eq_u32 s50, 3
    s_cselect_b32 s48, 2, 0
    s_xor_b32 s42, s42, 1
    s_or_b32 s48, s48, s42
    s_bitcmp1_b32 s69, s48
    s_cselect_b32 s50, 1, 0
    s_xor_b32 s48, s48, s50
    s_lshl_b32 s50, s48, 8
    s_add_u32 s50, s50, s68
    v_mov_b32 v37, s50
    s_lshl_b64 exec, 1, s49
    global_atomic_add v40, v37, v38, s[18:19] sc0
    s_mov_b64 exec, -1
    s_xor_b32 s49, s49, 1
    s_mov_b32 s67, s48
L_sv1:
    s_mov_b64 exec, 1
    s_waitcnt lgkmcnt(0)
    v_xor_b32 v25, 0x60, v25
    s_branch L_put
L_skv:
    s_mov_b32 s89, s91
    s_mov_b32 s91, s92
    s_mov_b32 s92, s93
    s_mov_b32 s93, s94
    s_mov_b32 s94, -1
    s_cmp_lg_u32 s89, -1
    s_cbranch_scc1 L_skv1
    s_and_b32 s50, s69, 3
    s_cmp_eq_u32 s50, 3
    s_cselect_b32 s48, 2, 0
    s_xor_b32 s42, s42, 1
    s_or_b32 s48, s48, s42
    s_bitcmp1_b32 s69, s48
    s_cselect_b32 s50, 1, 0
    s_xor_b32 s48, s48, s50
    s_lshl_b32 s50, s48, 8
    s_add_u32 s50, s50, s68
    v_mov_b32 v37, s50
    s_lshl_b64 exec, 1, s49
    global_atomic_add v40, v37, v38, s[18:19] sc0
    s_mov_b64 exec, -1
    s_xor_b32 s49, s49, 1
    s_waitcnt vmcnt(1)
    v_readlane_b32 s51, v40, s49
    s_mov_b32 s50, s67
    s_mov_b32 s67, s48
    s_cmp_ge_u32 s50, 2
    s_cbranch_scc1 L_skv2
    s_cmp_lg_u32 s57, 2
    s_cbranch_scc1 L_no2k
    s_add_u32 s52, s51, 1
    s_and_b32 s54, s52, -2
    s_add_u32 s54, s54, s50
    s_and_b32 s53, s52, 1
    s_lshl1_add_u32 s55, s54, s53
    s_add_u32 s53, s55, s39
    s_cmp_lt_u32 s55, s86
    s_cselect_b32 s90, s53, -1
    s_cmp_lg_u32 s90, -1
    s_cbranch_scc0 L_no2k
    s_mov_b32 s94, s93
    s_mov_b32 s93, s92
    s_mov_b32 s92, s91
    s_mov_b32 s91, s90
L_no2k:
    s_mov_b32 s57, 0
    s_and_b32 s54, s51, -2
    s_add_u32 s54, s54, s50
    s_and_b32 s53, s51, 1
    s_lshl1_add_u32 s55, s54, s53
    s_add_u32 s53, s55, s39
    s_cmp_lt_u32 s55, s86
    s_cselect_b32 s89, s53, -1
    s_cbranch_scc1 L_skv1
    s_branch L_skv3
L_skv2:
    s_lshl1_add_u32 s89, s51, s87
    s_and_b32 s51, s50, 1
    s_add_u32 s89, s89, s51
    s_cmp_lt_u32 s89, s37
    s_cbranch_scc1 L_skv1
L_skv3:
    s_bitset1_b32 s69, s50
    s_cmp_eq_u32 s69, 15
    s_cbranch_scc1 L_fterm
L_putempty:
    v_mov_b32 v25, 0x80000000
    s_branch L_put
L_skv1:
    s_mov_b32 s90, s89
    s_mov_b32 s55, 0
L_lookup:
    v_mov_b32 v28, s90
    v_writelane_b32 v28, s89, 0
    v_subrev_u32 v29, s34, v28
    v_min_u32 v29, 0x7ff, v29
    v_lshlrev_b32 v29, 2, v29
    ds_read_b32 v29, v29 offset:16384
    v_cmp_gt_u32 s[44:45], s34, v28
    v_cmp_gt_u32 s[46:47], s37, v28
    s_waitcnt lgkmcnt(0)
    v_cndmask_b32 v29, v29, v28, s[44:45]
    v_and_b32 v29, 0x7ff, v29
    v_lshlrev_b32 v30, 2, v29
    ds_read2st64_b32 v[26:27], v30 offset0:0 offset1:32
    v_lshlrev_b32 v29, 4, v29
    v_sub_u32 v30, s28, v29
    v_sub_u32 v31, s29, v29
    v_med3_i32 v30, v30, 0, 16
    v_med3_i32 v31, v31, 0, 16
    v_cndmask_b32 v30, 0, v30, s[44:45]
    v_lshlrev_b32 v31, 8, v31
    s_waitcnt lgkmcnt(0)
    v_cndmask_b32 v26, v27, v26, s[44:45]
    v_cmp_eq_u32 vcc, v26, v27
    v_lshl_or_b32 v25, v26, 16, v30
    v_mov_b32 v29, 0x80000000
    v_cndmask_b32 v31, 0, v31, vcc
    v_or_b32 v25, v25, v31
    v_cndmask_b32 v25, v29, v25, s[46:47]
    s_mov_b64 exec, 1
    v_or_b32 v25, s55, v25
    s_cmp_eq_u32 s55, 0
    s_cbranch_scc1 L_put
    s_mov_b64 exec, 3
    ds_write_b32 v7, v25
    v_add_u32 v7, 8, v7
L_put:
    s_mov_b64 exec, 3
    ds_write_b32 v6, v25
    s_mov_b64 exec, -1
    v_xor_b32 v6, 8, v6
    s_waitcnt lgkmcnt(0)
    s_barrier
    s_branch L_sloop
L_fterm:
    s_cmp_lg_u32 s43, 0
    s_cbranch_scc1 L_fterm3
    s_mov_b32 s51, 0
L_pollt:
    global_load_dword v32, v36, s[16:17] sc1
    s_add_u32 s51, s51, 1
    s_waitcnt vmcnt(0)
    v_readfirstlane_b32 s52, v32
    s_cmp_ge_u32 s51, 0x80000
    s_cbranch_scc1 L_polledt
    s_cmp_eq_u32 s52, 0
    s_cbranch_scc1 L_pollt
L_polledt:
    s_mov_b32 s43, 1
L_fterm3:
    v_mov_b32 v25, 0x80004000
    v_mov_b32 v26, 24832
    s_mov_b64 exec, 3
    ds_write_b32 v6, v25
    ds_write_b32 v26, v32 offset:16
    s_mov_b32 s51, 0
    s_mov_b32 s52, 0x0c0c0400
    s_mov_b32 s53, 0x04000c0c
    s_bfm_b64 exec, 8, 0
    s_waitcnt lgkmcnt(0)
    s_barrier
    s_barrier
    global_atomic_add v72, v62, v38, s[18:19] sc0
    s_mov_b64 exec, 1
    s_barrier
    s_waitcnt vmcnt(0)
    v_readfirstlane_b32 s50, v72
    s_cmp_ge_u32 s50, 63
    s_cbranch_scc1 L_p2
L_p1:
    global_load_dword v72, v63, s[18:19] sc1
    s_add_u32 s51, s51, 1
    s_waitcnt vmcnt(0)
    v_readfirstlane_b32 s50, v72
    s_cmp_ge_u32 s51, 0x80000
    s_cbranch_scc1 L_p2
    s_cmp_lt_u32 s50, 64
    s_cbranch_scc1 L_p1
L_p2:
    s_mov_b64 exec, -1
    global_load_dwordx4 v[108:111], v64, s[18:19] offset:0 sc1
    global_load_dwordx4 v[112:115], v64, s[18:19] offset:2048 sc1
    global_load_dwordx4 v[116:119], v65, s[18:19] offset:0 sc1
    global_load_dwordx4 v[120:123], v65, s[18:19] offset:2048 sc1
    global_load_dwordx4 v[124:127], v66, s[18:19] offset:0 sc1
    global_load_dwordx4 v[128:131], v66, s[18:19] offset:2048 sc1
    global_load_dwordx4 v[132:135], v67, s[18:19] offset:0 sc1
    global_load_dwordx4 v[136:139], v67, s[18:19] offset:2048 sc1
    global_load_dwordx4 v[76:79], v57, s[18:19] offset:0 sc1
    global_load_dwordx4 v[80:83], v57, s[18:19] offset:1024 sc1
    global_load_dwordx4 v[84:87], v57, s[18:19] offset:2048 sc1
    global_load_dwordx4 v[88:91], v57, s[18:19] offset:3072 sc1
    global_load_dwordx4 v[92:95], v58, s[18:19] offset:0 sc1
    global_load_dwordx4 v[96:99], v58, s[18:19] offset:1024 sc1
    global_load_dwordx4 v[100:103], v58, s[18:19] offset:2048 sc1
    global_load_dwordx4 v[104:107], v58, s[18:19] offset:3072 sc1
    s_add_u32 s51, s51, 1
    s_waitcnt vmcnt(8)
    v_max3_f32 v140, v108, v112, v116
    v_max3_f32 v141, v120, v124, v128
    v_max3_f32 v140, v140, v132, v136
    v_max_f32 v140, v140, v141
    s_nop 1
    v_max_f32_dpp v140, v140, v140 row_ror:8 row_mask:0xf bank_mask:0xf
    v_mov_b32 v141, v140
    s_nop 1
    v_permlane16_swap_b32 v140, v141
    v_max_f32 v140, v140, v141
    v_mov_b32 v141, v140
    s_nop 1
    v_permlane32_swap_b32 v140, v141
    v_max_f32 v140, v140, v141
    v_sub_f32 v152, v108, v140
    v_sub_f32 v153, v112, v140
    v_sub_f32 v154, v116, v140
    v_sub_f32 v155, v120, v140
    v_sub_f32 v156, v124, v140
    v_sub_f32 v157, v128, v140
    v_sub_f32 v158, v132, v140
    v_sub_f32 v159, v136, v140
    v_exp_f32 v152, v152
    v_exp_f32 v153, v153
    v_exp_f32 v154, v154
    v_exp_f32 v155, v155
    v_exp_f32 v156, v156
    v_exp_f32 v157, v157
    v_exp_f32 v158, v158
    v_exp_f32 v159, v159
    v_mul_f32 v146, v152, v109
    v_fmac_f32 v146, v153, v113
    v_fmac_f32 v146, v154, v117
    v_fmac_f32 v146, v155, v121
    v_fmac_f32 v146, v156, v125
    v_fmac_f32 v146, v157, v129
    v_fmac_f32 v146, v158, v133
    v_fmac_f32 v146, v159, v137
    v_xor_b32 v160, v32, v110
    v_xor_b32 v161, v32, v114
    v_or_b32 v160, v160, v161
    v_xor_b32 v161, v32, v118
    v_or_b32 v160, v160, v161
    v_xor_b32 v161, v32, v122
    v_or_b32 v160, v160, v161
    v_xor_b32 v161, v32, v126
    v_or_b32 v160, v160, v161
    v_xor_b32 v161, v32, v130
    v_or_b32 v160, v160, v161
    v_xor_b32 v161, v32, v134
    v_or_b32 v160, v160, v161
    v_xor_b32 v161, v32, v138
    v_or_b32 v160, v160, v161
    s_waitcnt vmcnt(7)
    v_perm_b32 v161, v77, v76, s52
    v_perm_b32 v162, v79, v78, s53
    v_xor_b32 v161, v32, v161
    v_xor_b32 v161, v161, v162
    v_or_b32 v160, v160, v161
    v_mul_f32 v142, v152, v76
    v_mul_f32 v143, v152, v77
    v_mul_f32 v144, v152, v78
    v_mul_f32 v145, v152, v79
    s_waitcnt vmcnt(6)
    v_perm_b32 v161, v81, v80, s52
    v_perm_b32 v162, v83, v82, s53
    v_xor_b32 v161, v32, v161
    v_xor_b32 v161, v161, v162
    v_or_b32 v160, v160, v161
    v_fmac_f32 v142, v153, v80
    v_fmac_f32 v143, v153, v81
    v_fmac_f32 v144, v153, v82
    v_fmac_f32 v145, v153, v83
    s_waitcnt vmcnt(5)
    v_perm_b32 v161, v85, v84, s52
    v_perm_b32 v162, v87, v86, s53
    v_xor_b32 v161, v32, v161
    v_xor_b32 v161, v161, v162
    v_or_b32 v160, v160, v161
    v_fmac_f32 v142, v154, v84
    v_fmac_f32 v143, v154, v85
    v_fmac_f32 v144, v154, v86
    v_fmac_f32 v145, v154, v87
    s_waitcnt vmcnt(4)
    v_perm_b32 v161, v89, v88, s52
    v_perm_b32 v162, v91, v90, s53
    v_xor_b32 v161, v32, v161
    v_xor_b32 v161, v161, v162
    v_or_b32 v160, v160, v161
    v_fmac_f32 v142, v155, v88
    v_fmac_f32 v143, v155, v89
    v_fmac_f32 v144, v155, v90
    v_fmac_f32 v145, v155, v91
    s_waitcnt vmcnt(3)
    v_perm_b32 v161, v93, v92, s52
    v_perm_b32 v162, v95, v94, s53
    v_xor_b32 v161, v32, v161
    v_xor_b32 v161, v161, v162
    v_or_b32 v160, v160, v161
    v_fmac_f32 v142, v156, v92
    v_fmac_f32 v143, v156, v93
    v_fmac_f32 v144, v156, v94
    v_fmac_f32 v145, v156, v95
    s_waitcnt vmcnt(2)
    v_perm_b32 v161, v97, v96, s52
    v_perm_b32 v162, v99, v98, s53
    v_xor_b32 v161, v32, v161
    v_xor_b32 v161, v161, v162
    v_or_b32 v160, v160, v161
    v_fmac_f32 v142, v157, v96
    v_fmac_f32 v143, v157, v97
    v_fmac_f32 v144, v157, v98
    v_fmac_f32 v145, v157, v99
    s_waitcnt vmcnt(1)
    v_perm_b32 v161, v101, v100, s52
    v_perm_b32 v162, v103, v102, s53
    v_xor_b32 v161, v32, v161
    v_xor_b32 v161, v161, v162
    v_or_b32 v160, v160, v161
    v_fmac_f32 v142, v158, v100
    v_fmac_f32 v143, v158, v101
    v_fmac_f32 v144, v158, v102
    v_fmac_f32 v145, v158, v103
    s_waitcnt vmcnt(0)
    v_perm_b32 v161, v105, v104, s52
    v_perm_b32 v162, v107, v106, s53
    v_xor_b32 v161, v32, v161
    v_xor_b32 v161, v161, v162
    v_or_b32 v160, v160, v161
    v_fmac_f32 v142, v159, v104
    v_fmac_f32 v143, v159, v105
    v_fmac_f32 v144, v159, v106
    v_fmac_f32 v145, v159, v107
    v_cmp_ne_u32 vcc, 0, v160
    s_nop 1
    v_add_f32_dpp v142, v142, v142 row_ror:8 row_mask:0xf bank_mask:0xf
    v_add_f32_dpp v143, v143, v143 row_ror:8 row_mask:0xf bank_mask:0xf
    v_add_f32_dpp v144, v144, v144 row_ror:8 row_mask:0xf bank_mask:0xf
    v_add_f32_dpp v145, v145, v145 row_ror:8 row_mask:0xf bank_mask:0xf
    v_add_f32_dpp v146, v146, v146 row_ror:8 row_mask:0xf bank_mask:0xf
    v_mov_b32 v147, v142
    v_mov_b32 v148, v143
    v_mov_b32 v149, v144
    v_mov_b32 v150, v145
    v_mov_b32 v151, v146
    s_nop 1
    v_permlane16_swap_b32 v142, v147
    v_permlane16_swap_b32 v143, v148
    v_permlane16_swap_b32 v144, v149
    v_permlane16_swap_b32 v145, v150
    v_permlane16_swap_b32 v146, v151
    v_add_f32 v142, v142, v147
    v_add_f32 v143, v143, v148
    v_add_f32 v144, v144, v149
    v_add_f32 v145, v145, v150
    v_add_f32 v146, v146, v151
    v_mov_b32 v147, v142
    v_mov_b32 v148, v143
    v_mov_b32 v149, v144
    v_mov_b32 v150, v145
    v_mov_b32 v151, v146
    s_nop 1
    v_permlane32_swap_b32 v142, v147
    v_permlane32_swap_b32 v143, v148
    v_permlane32_swap_b32 v144, v149
    v_permlane32_swap_b32 v145, v150
    v_permlane32_swap_b32 v146, v151
    v_add_f32 v142, v142, v147
    v_add_f32 v143, v143, v148
    v_add_f32 v144, v144, v149
    v_add_f32 v145, v145, v150
    v_add_f32 v146, v146, v151
    v_rcp_f32 v146, v146
    s_nop 0
    v_mul_f32 v142, v146, v142
    v_mul_f32 v143, v146, v143
    v_mul_f32 v144, v146, v144
    v_mul_f32 v145, v146, v145
    v_cvt_pk_bf16_f32 v148, v142, v143
    v_cvt_pk_bf16_f32 v149, v144, v145
    s_cmp_ge_u32 s51, 0x80000
    s_cbranch_scc1 L_fin
    s_cbranch_vccnz L_p2
L_fin:
    s_mov_b64 exec, 0xff
    global_store_dwordx2 v60, v[148:149], s[14:15]
    s_endpgm
L_code_end:
.section .rodata,"a"
.p2align 6
.amdhsa_kernel standalone__paged_block_table_kv_radixattention__decode_kernel
  .amdhsa_next_free_vgpr 168
  .amdhsa_next_free_sgpr 101
  .amdhsa_accum_offset 168
  .amdhsa_group_segment_fixed_size 0
  .amdhsa_kernarg_size 64
  .amdhsa_user_sgpr_count 2
  .amdhsa_user_sgpr_kernarg_segment_ptr 1
  .amdhsa_system_sgpr_workgroup_id_x 1
.end_amdhsa_kernel
```
